```python
import torch

def _softmax(x, axis=-1):
    return torch.softmax(x, dim=axis)
def _gelu(x):
    return torch.nn.functional.gelu(x, approximate="tanh")
def _silu(x):
    return torch.nn.functional.silu(x)
def _sigmoid(x):
    return torch.sigmoid(x)
def _layernorm(x, axis=-1, eps=1e-5):
    m = x.mean(dim=axis, keepdim=True)
    v = x.var(dim=axis, keepdim=True, unbiased=False)
    return (x - m) / torch.sqrt(v + eps)
def _scatter_add(tgt, idx, src, axis=0):
    return tgt.clone().index_add_(axis, idx, src)
def _segment_sum(src, seg, n):
    out = torch.zeros((n,) + src.shape[1:], dtype=src.dtype)
    return out.index_add_(0, seg, src)
def _pad(x, pw):
    flat = tuple(v for pair in reversed(pw) for v in pair)
    return torch.nn.functional.pad(x, flat)

kernel_name = 'parallel_sum__gqa_block_cached__glu_gated_swiglu__decode'

def setup_inputs():

    _w = (lambda a: (lambda t: t.to(torch.bfloat16) if t.is_floating_point() else t)(torch.as_tensor(a)))
    def _A_setup():
        B, Sq, D = 2, 1, 448
        Hq, Hkv, Sk, Dh = 16, 8, 32768, 256
        assert Hq % Hkv == 0, (Hq, Hkv)
        return {
            "x": _w((lambda *s: torch.randn(*s, dtype=torch.bfloat16) * 0.05)(B, Sq, D)),
            "k_cache": _w((lambda *s: torch.randn(*s, dtype=torch.bfloat16) * 3.2)(B, Hkv, Sk, Dh)),
            "v_cache": _w((lambda *s: torch.randn(*s, dtype=torch.bfloat16) * 1.6)(B, Hkv, Sk, Dh)),
            "wq": _w((lambda *s: torch.randn(*s, dtype=torch.bfloat16) * 3.2)(D, Hq * Dh) * (D ** -0.5)),
            "wo": _w((lambda *s: torch.randn(*s, dtype=torch.bfloat16) * 1.6)(Hq * Dh, D) * ((Hq * Dh) ** -0.5)),
        }
    _A_in = _A_setup()

    def _B_setup():
        B, S, D, F = 2, 1, 448, 1792
        return {
            "x": _w((lambda *s: torch.randn(*s, dtype=torch.bfloat16) * 0.05)(B, S, D)),
            "w1": _w((lambda *s: torch.randn(*s, dtype=torch.bfloat16) * 1.6)(D, F) * (2.0 / D) ** 0.5),
            "w3": _w((lambda *s: torch.randn(*s, dtype=torch.bfloat16) * 1.6)(D, F) * (2.0 / D) ** 0.5),
            "w2": _w((lambda *s: torch.randn(*s, dtype=torch.bfloat16) * 1.6)(F, D) * (2.0 / F) ** 0.5),
        }
    _B_in = _B_setup()

    return {
        "A_x": _A_in["x"],
        "A_k_cache": _A_in["k_cache"],
        "A_v_cache": _A_in["v_cache"],
        "A_wq": _A_in["wq"],
        "A_wo": _A_in["wo"],
        "B_x": _B_in["x"],
        "B_w1": _B_in["w1"],
        "B_w3": _B_in["w3"],
        "B_w2": _B_in["w2"],
    }

def reference(A_x, A_k_cache, A_v_cache, A_wq, A_wo, B_x, B_w1, B_w3, B_w2):
    def _A_ref(x, k_cache, v_cache, wq, wo):
        B, Sq, D = x.shape
        Hq, Dh = 16, 256
        Hkv = k_cache.shape[1]
        rep = Hq // Hkv
        q = (lambda x, *d: x.permute(*d))((x @ wq).reshape(B, Sq, Hq, Dh), 0, 2, 1, 3)
        k = (lambda x, n, axis: torch.repeat_interleave(x, n, dim=axis))(k_cache, rep, axis=1)
        v = (lambda x, n, axis: torch.repeat_interleave(x, n, dim=axis))(v_cache, rep, axis=1)
        scores = torch.einsum("bhqd,bhkd->bhqk", q, k) * (Dh ** -0.5)
        p = _softmax(scores, axis=-1)
        o = torch.einsum("bhqk,bhkd->bhqd", p, v)
        return (lambda x, *d: x.permute(*d))(o, 0, 2, 1, 3).reshape(B, Sq, Hq * Dh) @ wo

    def _B_ref(x, w1, w3, w2):
        gate = torch.einsum("bsd,df->bsf", x, w1)
        up = torch.einsum("bsd,df->bsf", x, w3)
        h = _silu(gate) * up
        out = torch.einsum("bsf,fd->bsd", h, w2)
        return out

    x = A_x
    xn = _layernorm(x, axis=-1)
    return x + _A_ref(xn, A_k_cache, A_v_cache, A_wq, A_wo) + _B_ref(xn, B_w1, B_w3, B_w2)
```

```asm
; @launch grid=(256,1,1) block=(512,1,1) lds=93184
.amdgcn_target "amdgcn-amd-amdhsa--gfx950"
.text
.globl parallel_sum__gqa_block_cached__glu_gated_swiglu__decode_kernel
.p2align 8
.type parallel_sum__gqa_block_cached__glu_gated_swiglu__decode_kernel,@function
parallel_sum__gqa_block_cached__glu_gated_swiglu__decode_kernel:
    s_cmp_ge_u32 s2, 256
    s_cbranch_scc1 L_end
    s_load_dwordx16 s[4:19], s[0:1], 0
    s_load_dwordx8 s[20:27], s[0:1], 64
    v_lshrrev_b32 v1, 6, v0
    v_and_b32 v0, 63, v0
    v_readfirstlane_b32 s28, v1
    s_lshr_b32 s29, s2, 4
    s_and_b32 s30, s2, 15
    s_lshr_b32 s31, s2, 7
    s_and_b32 s32, s29, 7
    s_mov_b32 s62, 0x3db8aa3b
    v_lshlrev_b32 v27, 4, v0
    s_sub_u32 s58, s30, s29
    s_and_b32 s58, s58, 11
    s_cmp_eq_u32 s58, 0
    s_cselect_b32 s78, 0, 0
    s_sub_u32 s78, 96, s78
    s_cmp_lt_u32 s28, 4
    s_cbranch_scc1 L_stream
    s_setprio 3
    s_cmp_lg_u32 s28, 4
    s_cbranch_scc1 L_helper
    s_lshl_b32 s64, s31, 2
    s_lshr_b32 s58, s30, 2
    s_add_u32 s64, s64, s58
    s_lshl_b32 s58, s32, 3
    s_add_u32 s64, s64, s58
    s_and_b32 s65, s2, 3
    s_lshl_b32 s67, s29, 13
    s_add_u32 s69, s67, 0x1000
    v_lshrrev_b32 v1, 3, v0
    v_mul_u32_u24 v1, 114688, v1
    v_and_b32 v10, 7, v0
    v_lshl_add_u32 v1, v10, 4, v1
    v_mov_b32 v3, v1
    s_mul_i32 s58, s65, 917504
    s_lshl_b32 s59, s64, 7
    s_add_u32 s58, s58, s59
    s_waitcnt lgkmcnt(0)
    s_mov_b32 s40, s4
    s_mov_b32 s41, s5
    s_mov_b32 s42, 1792
    s_mov_b32 s43, 0x00020000
    v_lshrrev_b32 v1, 1, v0
    v_mul_u32_u24 v1, 28, v1
    v_and_b32 v10, 1, v0
    v_mul_u32_u24 v10, 896, v10
    v_add_u32 v1, v1, v10
    buffer_load_dwordx4 v[16:19], v1, s[40:43], 0 offen
    buffer_load_dwordx3 v[20:22], v1, s[40:43], 0 offen offset:16
    s_mov_b32 s44, s26
    s_mov_b32 s45, s27
    s_mov_b32 s46, 16777216
    s_mov_b32 s47, 0x00020000
    buffer_load_dwordx4 v[128:131], v27, s[44:47], s67 offen offset:0 sc1
    buffer_load_dwordx4 v[132:135], v27, s[44:47], s67 offen offset:1024 sc1
    buffer_load_dwordx4 v[136:139], v27, s[44:47], s67 offen offset:2048 sc1
    buffer_load_dwordx4 v[140:143], v27, s[44:47], s67 offen offset:3072 sc1
    buffer_load_dwordx4 v[144:147], v27, s[44:47], s69 offen offset:0 sc1
    buffer_load_dwordx4 v[148:151], v27, s[44:47], s69 offen offset:1024 sc1
    buffer_load_dwordx4 v[152:155], v27, s[44:47], s69 offen offset:2048 sc1
    buffer_load_dwordx4 v[156:159], v27, s[44:47], s69 offen offset:3072 sc1
    s_mov_b32 s36, s10
    s_mov_b32 s37, s11
    s_mov_b32 s38, 3670016
    s_mov_b32 s39, 0x00020000
    v_mov_b32 v1, v3
    buffer_load_dwordx4 v[64:67], v1, s[36:39], s58 offen nt
    s_add_u32 s58, s58, 8192
    buffer_load_dwordx4 v[68:71], v1, s[36:39], s58 offen nt
    s_add_u32 s58, s58, 8192
    buffer_load_dwordx4 v[72:75], v1, s[36:39], s58 offen nt
    s_add_u32 s58, s58, 8192
    buffer_load_dwordx4 v[76:79], v1, s[36:39], s58 offen nt
    s_add_u32 s58, s58, 8192
    buffer_load_dwordx4 v[80:83], v1, s[36:39], s58 offen nt
    s_add_u32 s58, s58, 8192
    buffer_load_dwordx4 v[84:87], v1, s[36:39], s58 offen nt
    s_add_u32 s58, s58, 8192
    buffer_load_dwordx4 v[88:91], v1, s[36:39], s58 offen nt
    s_add_u32 s58, s58, 8192
    buffer_load_dwordx4 v[92:95], v1, s[36:39], s58 offen nt
    s_add_u32 s58, s58, 8192
    buffer_load_dwordx4 v[96:99], v1, s[36:39], s58 offen nt
    s_add_u32 s58, s58, 8192
    buffer_load_dwordx4 v[100:103], v1, s[36:39], s58 offen nt
    s_add_u32 s58, s58, 8192
    buffer_load_dwordx4 v[104:107], v1, s[36:39], s58 offen nt
    s_add_u32 s58, s58, 8192
    buffer_load_dwordx4 v[108:111], v1, s[36:39], s58 offen nt
    s_add_u32 s58, s58, 8192
    buffer_load_dwordx4 v[112:115], v1, s[36:39], s58 offen nt
    s_add_u32 s58, s58, 8192
    buffer_load_dwordx4 v[116:119], v1, s[36:39], s58 offen nt
    v_lshrrev_b32 v2, 5, v0
    v_lshlrev_b32 v2, 16, v2
    v_and_b32 v3, 7, v0
    v_lshl_add_u32 v2, v3, 5, v2
    v_and_b32 v3, 16, v0
    v_add_u32 v2, v2, v3
    v_and_b32 v3, 8, v0
    v_cmp_eq_u32 vcc, 0, v3
    v_mov_b32 v9, 0x7fffff00
    s_nop 0
    v_cndmask_b32 v2, v9, v2, vcc
    s_lshr_b32 s66, s64, 3
    s_lshl_b32 s66, s66, 13
    s_lshl_b32 s58, s65, 11
    s_add_u32 s66, s66, s58
    s_and_b32 s58, s64, 7
    s_lshl_b32 s58, s58, 8
    s_add_u32 s66, s66, s58
    buffer_load_dwordx4 v[120:123], v2, s[44:47], s66 offen sc1
    s_add_u32 s58, s32, 32
    s_lshr_b32 s59, s2, 3
    s_and_b32 s68, s30, 7
    s_cmp_eq_u32 s68, 0
    s_cselect_b32 s58, s59, s58
    s_mul_i32 s58, s58, 4352
    s_add_u32 s58, s58, 5242880
    s_lshl_b32 s59, s31, 1
    s_max_u32 s59, s59, s30
    s_cmp_eq_u32 s68, 0
    s_cselect_b32 s59, 1, s59
    s_cmp_eq_u32 s59, 1
    s_cselect_b32 s58, s58, 16777216
    v_mov_b32 v8, 0
    v_mov_b32 v124, 0
    v_mov_b32 v125, 0
    buffer_store_dwordx2 v[124:125], v8, s[44:47], s58 offen sc1
    s_branch L_hw0
L_stream:
    v_bfe_u32 v2, v0, 2, 2
    v_lshlrev_b32 v2, 9, v2
    v_lshrrev_b32 v3, 4, v0
    v_lshlrev_b32 v1, 6, v3
    v_and_b32 v52, 3, v0
    v_lshlrev_b32 v52, 4, v52
    v_add3_u32 v2, v2, v1, v52
    v_lshlrev_b32 v3, 9, v3
    v_and_b32 v52, 15, v0
    v_lshlrev_b32 v52, 4, v52
    v_add_u32 v3, v3, v52
    v_add_u32 v60, 0x1000, v2
    s_lshl_b32 s58, s29, 24
    s_lshl_b32 s79, s30, 7
    s_add_u32 s54, s79, s28
    s_lshl_b32 s59, s54, 13
    s_waitcnt lgkmcnt(0)
    s_add_u32 s36, s6, s58
    s_addc_u32 s37, s7, 0
    s_mov_b32 s38, 16777216
    s_mov_b32 s39, 0x00020000
    s_add_u32 s40, s8, s58
    s_addc_u32 s41, s9, 0
    s_mov_b32 s42, 16777216
    s_mov_b32 s43, 0x00020000
    buffer_load_dwordx4 v[64:67], v2, s[36:39], s59 offen offset:0 nt
    buffer_load_dwordx4 v[68:71], v2, s[36:39], s59 offen offset:256 nt
    buffer_load_dwordx4 v[72:75], v2, s[36:39], s59 offen offset:2048 nt
    buffer_load_dwordx4 v[76:79], v2, s[36:39], s59 offen offset:2304 nt
    buffer_load_dwordx4 v[80:83], v60, s[36:39], s59 offen offset:0 nt
    buffer_load_dwordx4 v[84:87], v60, s[36:39], s59 offen offset:256 nt
    v_and_b32 v1, 1, v0
    v_lshlrev_b32 v1, 4, v1
    v_mov_b32 v52, 0xffff
    v_lshlrev_b32 v52, v1, v52
    v_bfe_u32 v1, v0, 1, 2
    v_cmp_eq_u32 vcc, 0, v1
    s_nop 1
    v_cndmask_b32 v4, 0, v52, vcc
    v_cmp_eq_u32 vcc, 1, v1
    s_nop 1
    v_cndmask_b32 v5, 0, v52, vcc
    v_cmp_eq_u32 vcc, 2, v1
    s_nop 1
    v_cndmask_b32 v6, 0, v52, vcc
    v_cmp_eq_u32 vcc, 3, v1
    s_nop 1
    v_cndmask_b32 v7, 0, v52, vcc
    v_mov_b32 v24, 0xff800000
    v_mov_b32 v26, 0
    v_mov_b32 v29, 0
    s_mov_b32 s35, 0
    v_mov_b32 v16, 0
    v_mov_b32 v17, 0
    v_mov_b32 v18, 0
    v_mov_b32 v19, 0
    v_mov_b32 v20, 0
    v_mov_b32 v21, 0
    v_mov_b32 v22, 0
    v_mov_b32 v23, 0
    s_mov_b32 s44, s26
    s_mov_b32 s45, s27
    s_mov_b32 s46, 16777216
    s_mov_b32 s47, 0x00020000
    s_mov_b32 s63, 0xbdb8aa3b
    s_mov_b32 s72, -1
    s_mov_b32 s73, 0
    v_bfe_u32 v1, v0, 3, 1
    v_lshlrev_b32 v1, 9, v1
    v_lshrrev_b32 v52, 4, v0
    v_lshl_add_u32 v1, v52, 6, v1
    v_and_b32 v52, 3, v0
    v_lshl_add_u32 v1, v52, 4, v1
    v_mov_b32 v57, 0
    v_mov_b32 v59, 1
    v_and_b32 v61, 56, v0
    v_mov_b32 v56, 8
    s_mov_b32 s56, 0
    s_mov_b32 s66, 15360
    s_mov_b32 s67, 27648
    s_mov_b32 s77, 0
    s_mov_b32 s34, 0
    s_barrier
    s_cmp_lg_u32 s34, 0
    s_cbranch_scc1 L_thr_1
    ds_read_b32 v54, v57 offset:4
    s_waitcnt vmcnt(5) lgkmcnt(0)
    v_readfirstlane_b32 s34, v54
L_thr_1:
    buffer_load_dwordx4 v[88:91], v60, s[36:39], s59 offen offset:2048 nt
    s_cmp_lg_u32 s34, 0
    s_cbranch_scc1 L_thr_2
    ds_read_b32 v54, v57 offset:4
    s_waitcnt vmcnt(5) lgkmcnt(0)
    v_readfirstlane_b32 s34, v54
L_thr_2:
    buffer_load_dwordx4 v[92:95], v60, s[36:39], s59 offen offset:2304 nt
    s_add_u32 s59, s59, 0x8000
    s_cmp_lg_u32 s34, 0
    s_cbranch_scc1 L_thr_3
    ds_read_b32 v54, v57 offset:4
    s_waitcnt vmcnt(5) lgkmcnt(0)
    v_readfirstlane_b32 s34, v54
L_thr_3:
    buffer_load_dwordx4 v[96:99], v2, s[36:39], s59 offen offset:0 nt
    s_cmp_lg_u32 s34, 0
    s_cbranch_scc1 L_thr_4
    ds_read_b32 v54, v57 offset:4
    s_waitcnt vmcnt(5) lgkmcnt(0)
    v_readfirstlane_b32 s34, v54
L_thr_4:
    buffer_load_dwordx4 v[100:103], v2, s[36:39], s59 offen offset:256 nt
    s_cmp_lg_u32 s34, 0
    s_cbranch_scc1 L_thr_5
    ds_read_b32 v54, v57 offset:4
    s_waitcnt vmcnt(5) lgkmcnt(0)
    v_readfirstlane_b32 s34, v54
L_thr_5:
    buffer_load_dwordx4 v[104:107], v2, s[36:39], s59 offen offset:2048 nt
    s_cmp_lg_u32 s34, 0
    s_cbranch_scc1 L_thr_6
    ds_read_b32 v54, v57 offset:4
    s_waitcnt vmcnt(5) lgkmcnt(0)
    v_readfirstlane_b32 s34, v54
L_thr_6:
    buffer_load_dwordx4 v[108:111], v2, s[36:39], s59 offen offset:2304 nt
    s_cmp_lg_u32 s34, 0
    s_cbranch_scc1 L_thr_7
    ds_read_b32 v54, v57 offset:4
    s_waitcnt vmcnt(5) lgkmcnt(0)
    v_readfirstlane_b32 s34, v54
L_thr_7:
    buffer_load_dwordx4 v[112:115], v60, s[36:39], s59 offen offset:0 nt
    s_cmp_lg_u32 s34, 0
    s_cbranch_scc1 L_thr_8
    ds_read_b32 v54, v57 offset:4
    s_waitcnt vmcnt(5) lgkmcnt(0)
    v_readfirstlane_b32 s34, v54
L_thr_8:
    buffer_load_dwordx4 v[116:119], v60, s[36:39], s59 offen offset:256 nt
    s_cmp_lg_u32 s34, 0
    s_cbranch_scc1 L_thr_9
    ds_read_b32 v54, v57 offset:4
    s_waitcnt vmcnt(5) lgkmcnt(0)
    v_readfirstlane_b32 s34, v54
L_thr_9:
    buffer_load_dwordx4 v[120:123], v60, s[36:39], s59 offen offset:2048 nt
    s_cmp_lg_u32 s34, 0
    s_cbranch_scc1 L_thr_10
    ds_read_b32 v54, v57 offset:4
    s_waitcnt vmcnt(5) lgkmcnt(0)
    v_readfirstlane_b32 s34, v54
L_thr_10:
    buffer_load_dwordx4 v[124:127], v60, s[36:39], s59 offen offset:2304 nt
    s_add_u32 s59, s59, 0x8000
    s_cmp_lg_u32 s34, 0
    s_cbranch_scc1 L_thr_11
    ds_read_b32 v54, v57 offset:4
    s_waitcnt vmcnt(5) lgkmcnt(0)
    v_readfirstlane_b32 s34, v54
L_thr_11:
    buffer_load_dwordx4 v[128:131], v2, s[36:39], s59 offen offset:0 nt
    s_cmp_lg_u32 s34, 0
    s_cbranch_scc1 L_thr_12
    ds_read_b32 v54, v57 offset:4
    s_waitcnt vmcnt(5) lgkmcnt(0)
    v_readfirstlane_b32 s34, v54
L_thr_12:
    buffer_load_dwordx4 v[132:135], v2, s[36:39], s59 offen offset:256 nt
    s_cmp_lg_u32 s34, 0
    s_cbranch_scc1 L_thr_13
    ds_read_b32 v54, v57 offset:4
    s_waitcnt vmcnt(5) lgkmcnt(0)
    v_readfirstlane_b32 s34, v54
L_thr_13:
    buffer_load_dwordx4 v[136:139], v2, s[36:39], s59 offen offset:2048 nt
    s_cmp_lg_u32 s34, 0
    s_cbranch_scc1 L_thr_14
    ds_read_b32 v54, v57 offset:4
    s_waitcnt vmcnt(5) lgkmcnt(0)
    v_readfirstlane_b32 s34, v54
L_thr_14:
    buffer_load_dwordx4 v[140:143], v2, s[36:39], s59 offen offset:2304 nt
    s_cmp_lg_u32 s34, 0
    s_cbranch_scc1 L_thr_15
    ds_read_b32 v54, v57 offset:4
    s_waitcnt vmcnt(5) lgkmcnt(0)
    v_readfirstlane_b32 s34, v54
L_thr_15:
    buffer_load_dwordx4 v[144:147], v60, s[36:39], s59 offen offset:0 nt
    s_cmp_lg_u32 s34, 0
    s_cbranch_scc1 L_thr_16
    ds_read_b32 v54, v57 offset:4
    s_waitcnt vmcnt(5) lgkmcnt(0)
    v_readfirstlane_b32 s34, v54
L_thr_16:
    buffer_load_dwordx4 v[148:151], v60, s[36:39], s59 offen offset:256 nt
    s_cmp_lg_u32 s34, 0
    s_cbranch_scc1 L_thr_17
    ds_read_b32 v54, v57 offset:4
    s_waitcnt vmcnt(5) lgkmcnt(0)
    v_readfirstlane_b32 s34, v54
L_thr_17:
    buffer_load_dwordx4 v[152:155], v60, s[36:39], s59 offen offset:2048 nt
    s_cmp_lg_u32 s34, 0
    s_cbranch_scc1 L_thr_18
    ds_read_b32 v54, v57 offset:4
    s_waitcnt vmcnt(5) lgkmcnt(0)
    v_readfirstlane_b32 s34, v54
L_thr_18:
    buffer_load_dwordx4 v[156:159], v60, s[36:39], s59 offen offset:2304 nt
    s_add_u32 s59, s59, 0x8000
    s_cmp_lg_u32 s34, 0
    s_cbranch_scc1 L_thr_19
    ds_read_b32 v54, v57 offset:4
    s_waitcnt vmcnt(5) lgkmcnt(0)
    v_readfirstlane_b32 s34, v54
L_thr_19:
    buffer_load_dwordx4 v[160:163], v2, s[36:39], s59 offen offset:0 nt
    s_cmp_lg_u32 s34, 0
    s_cbranch_scc1 L_thr_20
    ds_read_b32 v54, v57 offset:4
    s_waitcnt vmcnt(5) lgkmcnt(0)
    v_readfirstlane_b32 s34, v54
L_thr_20:
    buffer_load_dwordx4 v[164:167], v2, s[36:39], s59 offen offset:256 nt
    s_cmp_lg_u32 s34, 0
    s_cbranch_scc1 L_thr_21
    ds_read_b32 v54, v57 offset:4
    s_waitcnt vmcnt(5) lgkmcnt(0)
    v_readfirstlane_b32 s34, v54
L_thr_21:
    buffer_load_dwordx4 v[168:171], v2, s[36:39], s59 offen offset:2048 nt
    s_cmp_lg_u32 s34, 0
    s_cbranch_scc1 L_thr_22
    ds_read_b32 v54, v57 offset:4
    s_waitcnt vmcnt(5) lgkmcnt(0)
    v_readfirstlane_b32 s34, v54
L_thr_22:
    buffer_load_dwordx4 v[172:175], v2, s[36:39], s59 offen offset:2304 nt
    s_cmp_lg_u32 s34, 0
    s_cbranch_scc1 L_thr_23
    ds_read_b32 v54, v57 offset:4
    s_waitcnt vmcnt(5) lgkmcnt(0)
    v_readfirstlane_b32 s34, v54
L_thr_23:
    buffer_load_dwordx4 v[176:179], v60, s[36:39], s59 offen offset:0 nt
    s_cmp_lg_u32 s34, 0
    s_cbranch_scc1 L_thr_24
    ds_read_b32 v54, v57 offset:4
    s_waitcnt vmcnt(5) lgkmcnt(0)
    v_readfirstlane_b32 s34, v54
L_thr_24:
    buffer_load_dwordx4 v[180:183], v60, s[36:39], s59 offen offset:256 nt
    s_cmp_lg_u32 s34, 0
    s_cbranch_scc1 L_thr_25
    ds_read_b32 v54, v57 offset:4
    s_waitcnt vmcnt(5) lgkmcnt(0)
    v_readfirstlane_b32 s34, v54
L_thr_25:
    buffer_load_dwordx4 v[184:187], v60, s[36:39], s59 offen offset:2048 nt
    s_cmp_lg_u32 s34, 0
    s_cbranch_scc1 L_thr_26
    ds_read_b32 v54, v57 offset:4
    s_waitcnt vmcnt(5) lgkmcnt(0)
    v_readfirstlane_b32 s34, v54
L_thr_26:
    buffer_load_dwordx4 v[188:191], v60, s[36:39], s59 offen offset:2304 nt
    s_add_u32 s59, s59, 0x8000
    s_cmp_lg_u32 s34, 0
    s_cbranch_scc1 L_thr_27
    ds_read_b32 v54, v57 offset:4
    s_waitcnt vmcnt(5) lgkmcnt(0)
    v_readfirstlane_b32 s34, v54
L_thr_27:
    buffer_load_dwordx4 v[192:195], v2, s[36:39], s59 offen offset:0 nt
    s_cmp_lg_u32 s34, 0
    s_cbranch_scc1 L_thr_28
    ds_read_b32 v54, v57 offset:4
    s_waitcnt vmcnt(5) lgkmcnt(0)
    v_readfirstlane_b32 s34, v54
L_thr_28:
    buffer_load_dwordx4 v[196:199], v2, s[36:39], s59 offen offset:256 nt
    s_cmp_lg_u32 s34, 0
    s_cbranch_scc1 L_thr_29
    ds_read_b32 v54, v57 offset:4
    s_waitcnt vmcnt(5) lgkmcnt(0)
    v_readfirstlane_b32 s34, v54
L_thr_29:
    buffer_load_dwordx4 v[200:203], v2, s[36:39], s59 offen offset:2048 nt
    s_cmp_lg_u32 s34, 0
    s_cbranch_scc1 L_thr_30
    ds_read_b32 v54, v57 offset:4
    s_waitcnt vmcnt(5) lgkmcnt(0)
    v_readfirstlane_b32 s34, v54
L_thr_30:
    buffer_load_dwordx4 v[204:207], v2, s[36:39], s59 offen offset:2304 nt
    s_cmp_lg_u32 s34, 0
    s_cbranch_scc1 L_thr_31
    ds_read_b32 v54, v57 offset:4
    s_waitcnt vmcnt(5) lgkmcnt(0)
    v_readfirstlane_b32 s34, v54
L_thr_31:
    buffer_load_dwordx4 v[208:211], v60, s[36:39], s59 offen offset:0 nt
    s_cmp_lg_u32 s34, 0
    s_cbranch_scc1 L_thr_32
    ds_read_b32 v54, v57 offset:4
    s_waitcnt vmcnt(5) lgkmcnt(0)
    v_readfirstlane_b32 s34, v54
L_thr_32:
    buffer_load_dwordx4 v[212:215], v60, s[36:39], s59 offen offset:256 nt
    s_cmp_lg_u32 s34, 0
    s_cbranch_scc1 L_thr_33
    ds_read_b32 v54, v57 offset:4
    s_waitcnt vmcnt(5) lgkmcnt(0)
    v_readfirstlane_b32 s34, v54
L_thr_33:
    buffer_load_dwordx4 v[216:219], v60, s[36:39], s59 offen offset:2048 nt
    s_cmp_lg_u32 s34, 0
    s_cbranch_scc1 L_thr_34
    ds_read_b32 v54, v57 offset:4
    s_waitcnt vmcnt(5) lgkmcnt(0)
    v_readfirstlane_b32 s34, v54
L_thr_34:
    buffer_load_dwordx4 v[220:223], v60, s[36:39], s59 offen offset:2304 nt
    s_add_u32 s59, s59, 0x8000
    s_cmp_lg_u32 s34, 0
    s_cbranch_scc1 L_thr_35
    ds_read_b32 v54, v57 offset:4
    s_waitcnt vmcnt(5) lgkmcnt(0)
    v_readfirstlane_b32 s34, v54
L_thr_35:
    buffer_load_dwordx4 v[224:227], v2, s[36:39], s59 offen offset:0 nt
    s_cmp_lg_u32 s34, 0
    s_cbranch_scc1 L_thr_36
    ds_read_b32 v54, v57 offset:4
    s_waitcnt vmcnt(5) lgkmcnt(0)
    v_readfirstlane_b32 s34, v54
L_thr_36:
    buffer_load_dwordx4 v[228:231], v2, s[36:39], s59 offen offset:256 nt
    s_cmp_lg_u32 s34, 0
    s_cbranch_scc1 L_thr_37
    ds_read_b32 v54, v57 offset:4
    s_waitcnt vmcnt(5) lgkmcnt(0)
    v_readfirstlane_b32 s34, v54
L_thr_37:
    buffer_load_dwordx4 v[232:235], v2, s[36:39], s59 offen offset:2048 nt
    s_cmp_lg_u32 s34, 0
    s_cbranch_scc1 L_thr_38
    ds_read_b32 v54, v57 offset:4
    s_waitcnt vmcnt(5) lgkmcnt(0)
    v_readfirstlane_b32 s34, v54
L_thr_38:
    buffer_load_dwordx4 v[236:239], v2, s[36:39], s59 offen offset:2304 nt
    s_cmp_lg_u32 s34, 0
    s_cbranch_scc1 L_thr_39
    ds_read_b32 v54, v57 offset:4
    s_waitcnt vmcnt(5) lgkmcnt(0)
    v_readfirstlane_b32 s34, v54
L_thr_39:
    buffer_load_dwordx4 v[240:243], v60, s[36:39], s59 offen offset:0 nt
    s_cmp_lg_u32 s34, 0
    s_cbranch_scc1 L_thr_40
    ds_read_b32 v54, v57 offset:4
    s_waitcnt vmcnt(5) lgkmcnt(0)
    v_readfirstlane_b32 s34, v54
L_thr_40:
    buffer_load_dwordx4 v[244:247], v60, s[36:39], s59 offen offset:256 nt
    s_cmp_lg_u32 s34, 0
    s_cbranch_scc1 L_thr_41
    ds_read_b32 v54, v57 offset:4
    s_waitcnt vmcnt(5) lgkmcnt(0)
    v_readfirstlane_b32 s34, v54
L_thr_41:
    buffer_load_dwordx4 v[248:251], v60, s[36:39], s59 offen offset:2048 nt
    s_cmp_lg_u32 s34, 0
    s_cbranch_scc1 L_thr_42
    ds_read_b32 v54, v57 offset:4
    s_waitcnt vmcnt(5) lgkmcnt(0)
    v_readfirstlane_b32 s34, v54
L_thr_42:
    buffer_load_dwordx4 v[252:255], v60, s[36:39], s59 offen offset:2304 nt
    s_add_u32 s59, s59, 0x8000
    s_mov_b32 s68, s59
    s_lshl_b32 s58, s28, 6
    v_add_u32 v53, s58, v61
    s_add_u32 s65, s58, 20992
    s_mov_b32 s64, 0
    s_mov_b32 s76, 400000
L_lw_43:
    ds_read_b32 v54, v57 offset:4
    s_waitcnt lgkmcnt(0)
    v_readfirstlane_b32 s58, v54
    s_nop 0
    s_cmp_lg_u32 s58, 0
    s_cbranch_scc1 L_lwd_44
    s_sleep 1
    s_sub_u32 s76, s76, 1
    s_cmp_gt_i32 s76, 0
    s_cbranch_scc1 L_lw_43
L_lwd_44:
    ds_read_b128 v[8:11], v1 offset:256
    ds_read_b128 v[12:15], v1 offset:512
    s_mov_b64 exec, 1
    ds_add_rtn_u32 v58, v56, v59
    s_mov_b64 exec, -1
    s_waitcnt lgkmcnt(0)
    s_branch L_catchup
L_next:
    s_mov_b32 s59, 2048
    s_cmp_eq_u32 s56, 2
    s_cbranch_scc1 L_n_ret
L_n_again:
    s_waitcnt lgkmcnt(0)
    v_readfirstlane_b32 s55, v58
    s_mov_b64 exec, 1
    ds_add_rtn_u32 v58, v56, v59
    s_mov_b64 exec, -1
    s_add_u32 s59, s79, s55
    s_lshl_b32 s65, s55, 6
    s_add_u32 s65, s65, 19456
    s_cmp_lt_u32 s55, s78
    s_cbranch_scc1 L_n_have
    s_sub_u32 s55, s55, s78
    s_lshl_b32 s65, s55, 6
    s_add_u32 s65, s65, s67
    s_lshl_b32 s58, s55, 2
    s_add_u32 s58, s58, s66
    v_mov_b32 v55, s58
    s_mov_b32 s76, 400000
L_lw_45:
    ds_read_b32 v54, v55 offset:0
    s_waitcnt lgkmcnt(0)
    v_readfirstlane_b32 s58, v54
    s_nop 0
    s_cmp_lg_u32 s58, 0
    s_cbranch_scc1 L_lwd_46
    s_sleep 1
    s_sub_u32 s76, s76, 1
    s_cmp_gt_i32 s76, 0
    s_cbranch_scc1 L_lw_45
L_lwd_46:
    s_cmp_eq_u32 s58, 0
    s_cselect_b32 s59, 2048, s58
    s_cmp_lt_u32 s59, 2048
    s_cbranch_scc1 L_n_have
    s_add_u32 s56, s56, 1
    s_cmp_eq_u32 s56, 2
    s_cbranch_scc1 L_n_fin
    s_mov_b32 s36, s40
    s_mov_b32 s37, s41
    v_mov_b32 v2, v3
    v_add_u32 v60, 0x1000, v3
    v_mov_b32 v56, 16
    s_mov_b32 s66, 17408
    s_mov_b32 s67, 60416
    s_mov_b64 exec, 1
    ds_add_rtn_u32 v58, v56, v59
    s_mov_b64 exec, -1
    s_branch L_n_again
L_n_fin:
    s_mov_b64 exec, 1
    ds_add_u32 v57, v59 offset:12
    s_mov_b64 exec, -1
    s_setpc_b64 s[60:61]
L_n_have:
    s_cmp_eq_u32 s56, 0
    s_cbranch_scc1 L_n_ret
    v_add_u32 v1, s65, v61
    ds_read_b64 v[62:63], v1
    ds_read_b32 v25, v57 offset:24
L_n_ret:
    s_setpc_b64 s[60:61]
L_catchup:
    s_waitcnt vmcnt(44)
    v_mfma_f32_16x16x32_bf16 v[28:31], v[64:67], v[8:11], 0
    v_mfma_f32_16x16x32_bf16 v[32:35], v[72:75], v[8:11], 0
    v_mfma_f32_16x16x32_bf16 v[28:31], v[68:71], v[12:15], v[28:31]
    v_mfma_f32_16x16x32_bf16 v[32:35], v[76:79], v[12:15], v[32:35]
    buffer_load_dwordx4 v[64:67], v2, s[36:39], s68 offen offset:0 nt
    buffer_load_dwordx4 v[68:71], v2, s[36:39], s68 offen offset:256 nt
    buffer_load_dwordx4 v[72:75], v2, s[36:39], s68 offen offset:2048 nt
    buffer_load_dwordx4 v[76:79], v2, s[36:39], s68 offen offset:2304 nt
    s_nop 2
    v_mov_b32_dpp v36, v28 quad_perm:[0,0,0,0] row_mask:0xf bank_mask:0xf
    v_mov_b32_dpp v37, v32 quad_perm:[0,0,0,0] row_mask:0xf bank_mask:0xf
    s_nop 0
    v_add_f32_dpp v36, v29, v36 quad_perm:[1,1,1,1] row_mask:0xf bank_mask:0xf
    v_add_f32_dpp v37, v33, v37 quad_perm:[1,1,1,1] row_mask:0xf bank_mask:0xf
    s_nop 0
    v_add_f32_dpp v36, v30, v36 quad_perm:[2,2,2,2] row_mask:0xf bank_mask:0xf
    v_add_f32_dpp v37, v34, v37 quad_perm:[2,2,2,2] row_mask:0xf bank_mask:0xf
    s_nop 0
    v_add_f32_dpp v36, v31, v36 quad_perm:[3,3,3,3] row_mask:0xf bank_mask:0xf
    v_add_f32_dpp v37, v35, v37 quad_perm:[3,3,3,3] row_mask:0xf bank_mask:0xf
    v_cvt_pk_bf16_f32 v38, v36, v37
    v_min_u32 v38, -2, v38
    ds_write_b32 v53, v38 offset:19456
    s_waitcnt vmcnt(44)
    v_mfma_f32_16x16x32_bf16 v[28:31], v[80:83], v[8:11], 0
    v_mfma_f32_16x16x32_bf16 v[32:35], v[88:91], v[8:11], 0
    v_mfma_f32_16x16x32_bf16 v[28:31], v[84:87], v[12:15], v[28:31]
    v_mfma_f32_16x16x32_bf16 v[32:35], v[92:95], v[12:15], v[32:35]
    buffer_load_dwordx4 v[80:83], v60, s[36:39], s68 offen offset:0 nt
    buffer_load_dwordx4 v[84:87], v60, s[36:39], s68 offen offset:256 nt
    buffer_load_dwordx4 v[88:91], v60, s[36:39], s68 offen offset:2048 nt
    buffer_load_dwordx4 v[92:95], v60, s[36:39], s68 offen offset:2304 nt
    s_nop 2
    v_mov_b32_dpp v36, v28 quad_perm:[0,0,0,0] row_mask:0xf bank_mask:0xf
    v_mov_b32_dpp v37, v32 quad_perm:[0,0,0,0] row_mask:0xf bank_mask:0xf
    s_nop 0
    v_add_f32_dpp v36, v29, v36 quad_perm:[1,1,1,1] row_mask:0xf bank_mask:0xf
    v_add_f32_dpp v37, v33, v37 quad_perm:[1,1,1,1] row_mask:0xf bank_mask:0xf
    s_nop 0
    v_add_f32_dpp v36, v30, v36 quad_perm:[2,2,2,2] row_mask:0xf bank_mask:0xf
    v_add_f32_dpp v37, v34, v37 quad_perm:[2,2,2,2] row_mask:0xf bank_mask:0xf
    s_nop 0
    v_add_f32_dpp v36, v31, v36 quad_perm:[3,3,3,3] row_mask:0xf bank_mask:0xf
    v_add_f32_dpp v37, v35, v37 quad_perm:[3,3,3,3] row_mask:0xf bank_mask:0xf
    v_cvt_pk_bf16_f32 v38, v36, v37
    v_min_u32 v38, -2, v38
    ds_write_b32 v53, v38 offset:19460
    s_waitcnt vmcnt(44)
    v_mfma_f32_16x16x32_bf16 v[28:31], v[96:99], v[8:11], 0
    v_mfma_f32_16x16x32_bf16 v[32:35], v[104:107], v[8:11], 0
    v_mfma_f32_16x16x32_bf16 v[28:31], v[100:103], v[12:15], v[28:31]
    v_mfma_f32_16x16x32_bf16 v[32:35], v[108:111], v[12:15], v[32:35]
    s_nop 6
    v_mov_b32_dpp v36, v28 quad_perm:[0,0,0,0] row_mask:0xf bank_mask:0xf
    v_mov_b32_dpp v37, v32 quad_perm:[0,0,0,0] row_mask:0xf bank_mask:0xf
    s_nop 0
    v_add_f32_dpp v36, v29, v36 quad_perm:[1,1,1,1] row_mask:0xf bank_mask:0xf
    v_add_f32_dpp v37, v33, v37 quad_perm:[1,1,1,1] row_mask:0xf bank_mask:0xf
    s_nop 0
    v_add_f32_dpp v36, v30, v36 quad_perm:[2,2,2,2] row_mask:0xf bank_mask:0xf
    v_add_f32_dpp v37, v34, v37 quad_perm:[2,2,2,2] row_mask:0xf bank_mask:0xf
    s_nop 0
    v_add_f32_dpp v36, v31, v36 quad_perm:[3,3,3,3] row_mask:0xf bank_mask:0xf
    v_add_f32_dpp v37, v35, v37 quad_perm:[3,3,3,3] row_mask:0xf bank_mask:0xf
    v_cvt_pk_bf16_f32 v38, v36, v37
    v_min_u32 v38, -2, v38
    ds_write_b32 v53, v38 offset:19712
    s_waitcnt vmcnt(40)
    v_mfma_f32_16x16x32_bf16 v[28:31], v[112:115], v[8:11], 0
    v_mfma_f32_16x16x32_bf16 v[32:35], v[120:123], v[8:11], 0
    v_mfma_f32_16x16x32_bf16 v[28:31], v[116:119], v[12:15], v[28:31]
    v_mfma_f32_16x16x32_bf16 v[32:35], v[124:127], v[12:15], v[32:35]
    s_nop 6
    v_mov_b32_dpp v36, v28 quad_perm:[0,0,0,0] row_mask:0xf bank_mask:0xf
    v_mov_b32_dpp v37, v32 quad_perm:[0,0,0,0] row_mask:0xf bank_mask:0xf
    s_nop 0
    v_add_f32_dpp v36, v29, v36 quad_perm:[1,1,1,1] row_mask:0xf bank_mask:0xf
    v_add_f32_dpp v37, v33, v37 quad_perm:[1,1,1,1] row_mask:0xf bank_mask:0xf
    s_nop 0
    v_add_f32_dpp v36, v30, v36 quad_perm:[2,2,2,2] row_mask:0xf bank_mask:0xf
    v_add_f32_dpp v37, v34, v37 quad_perm:[2,2,2,2] row_mask:0xf bank_mask:0xf
    s_nop 0
    v_add_f32_dpp v36, v31, v36 quad_perm:[3,3,3,3] row_mask:0xf bank_mask:0xf
    v_add_f32_dpp v37, v35, v37 quad_perm:[3,3,3,3] row_mask:0xf bank_mask:0xf
    v_cvt_pk_bf16_f32 v38, v36, v37
    v_min_u32 v38, -2, v38
    ds_write_b32 v53, v38 offset:19716
    s_waitcnt vmcnt(36)
    v_mfma_f32_16x16x32_bf16 v[28:31], v[128:131], v[8:11], 0
    v_mfma_f32_16x16x32_bf16 v[32:35], v[136:139], v[8:11], 0
    v_mfma_f32_16x16x32_bf16 v[28:31], v[132:135], v[12:15], v[28:31]
    v_mfma_f32_16x16x32_bf16 v[32:35], v[140:143], v[12:15], v[32:35]
    s_nop 6
    v_mov_b32_dpp v36, v28 quad_perm:[0,0,0,0] row_mask:0xf bank_mask:0xf
    v_mov_b32_dpp v37, v32 quad_perm:[0,0,0,0] row_mask:0xf bank_mask:0xf
    s_nop 0
    v_add_f32_dpp v36, v29, v36 quad_perm:[1,1,1,1] row_mask:0xf bank_mask:0xf
    v_add_f32_dpp v37, v33, v37 quad_perm:[1,1,1,1] row_mask:0xf bank_mask:0xf
    s_nop 0
    v_add_f32_dpp v36, v30, v36 quad_perm:[2,2,2,2] row_mask:0xf bank_mask:0xf
    v_add_f32_dpp v37, v34, v37 quad_perm:[2,2,2,2] row_mask:0xf bank_mask:0xf
    s_nop 0
    v_add_f32_dpp v36, v31, v36 quad_perm:[3,3,3,3] row_mask:0xf bank_mask:0xf
    v_add_f32_dpp v37, v35, v37 quad_perm:[3,3,3,3] row_mask:0xf bank_mask:0xf
    v_cvt_pk_bf16_f32 v38, v36, v37
    v_min_u32 v38, -2, v38
    ds_write_b32 v53, v38 offset:19968
    s_waitcnt vmcnt(32)
    v_mfma_f32_16x16x32_bf16 v[28:31], v[144:147], v[8:11], 0
    v_mfma_f32_16x16x32_bf16 v[32:35], v[152:155], v[8:11], 0
    v_mfma_f32_16x16x32_bf16 v[28:31], v[148:151], v[12:15], v[28:31]
    v_mfma_f32_16x16x32_bf16 v[32:35], v[156:159], v[12:15], v[32:35]
    s_nop 6
    v_mov_b32_dpp v36, v28 quad_perm:[0,0,0,0] row_mask:0xf bank_mask:0xf
    v_mov_b32_dpp v37, v32 quad_perm:[0,0,0,0] row_mask:0xf bank_mask:0xf
    s_nop 0
    v_add_f32_dpp v36, v29, v36 quad_perm:[1,1,1,1] row_mask:0xf bank_mask:0xf
    v_add_f32_dpp v37, v33, v37 quad_perm:[1,1,1,1] row_mask:0xf bank_mask:0xf
    s_nop 0
    v_add_f32_dpp v36, v30, v36 quad_perm:[2,2,2,2] row_mask:0xf bank_mask:0xf
    v_add_f32_dpp v37, v34, v37 quad_perm:[2,2,2,2] row_mask:0xf bank_mask:0xf
    s_nop 0
    v_add_f32_dpp v36, v31, v36 quad_perm:[3,3,3,3] row_mask:0xf bank_mask:0xf
    v_add_f32_dpp v37, v35, v37 quad_perm:[3,3,3,3] row_mask:0xf bank_mask:0xf
    v_cvt_pk_bf16_f32 v38, v36, v37
    v_min_u32 v38, -2, v38
    ds_write_b32 v53, v38 offset:19972
    s_waitcnt vmcnt(28)
    v_mfma_f32_16x16x32_bf16 v[28:31], v[160:163], v[8:11], 0
    v_mfma_f32_16x16x32_bf16 v[32:35], v[168:171], v[8:11], 0
    v_mfma_f32_16x16x32_bf16 v[28:31], v[164:167], v[12:15], v[28:31]
    v_mfma_f32_16x16x32_bf16 v[32:35], v[172:175], v[12:15], v[32:35]
    s_nop 6
    v_mov_b32_dpp v36, v28 quad_perm:[0,0,0,0] row_mask:0xf bank_mask:0xf
    v_mov_b32_dpp v37, v32 quad_perm:[0,0,0,0] row_mask:0xf bank_mask:0xf
    s_nop 0
    v_add_f32_dpp v36, v29, v36 quad_perm:[1,1,1,1] row_mask:0xf bank_mask:0xf
    v_add_f32_dpp v37, v33, v37 quad_perm:[1,1,1,1] row_mask:0xf bank_mask:0xf
    s_nop 0
    v_add_f32_dpp v36, v30, v36 quad_perm:[2,2,2,2] row_mask:0xf bank_mask:0xf
    v_add_f32_dpp v37, v34, v37 quad_perm:[2,2,2,2] row_mask:0xf bank_mask:0xf
    s_nop 0
    v_add_f32_dpp v36, v31, v36 quad_perm:[3,3,3,3] row_mask:0xf bank_mask:0xf
    v_add_f32_dpp v37, v35, v37 quad_perm:[3,3,3,3] row_mask:0xf bank_mask:0xf
    v_cvt_pk_bf16_f32 v38, v36, v37
    v_min_u32 v38, -2, v38
    ds_write_b32 v53, v38 offset:20224
    s_waitcnt vmcnt(24)
    v_mfma_f32_16x16x32_bf16 v[28:31], v[176:179], v[8:11], 0
    v_mfma_f32_16x16x32_bf16 v[32:35], v[184:187], v[8:11], 0
    v_mfma_f32_16x16x32_bf16 v[28:31], v[180:183], v[12:15], v[28:31]
    v_mfma_f32_16x16x32_bf16 v[32:35], v[188:191], v[12:15], v[32:35]
    s_nop 6
    v_mov_b32_dpp v36, v28 quad_perm:[0,0,0,0] row_mask:0xf bank_mask:0xf
    v_mov_b32_dpp v37, v32 quad_perm:[0,0,0,0] row_mask:0xf bank_mask:0xf
    s_nop 0
    v_add_f32_dpp v36, v29, v36 quad_perm:[1,1,1,1] row_mask:0xf bank_mask:0xf
    v_add_f32_dpp v37, v33, v37 quad_perm:[1,1,1,1] row_mask:0xf bank_mask:0xf
    s_nop 0
    v_add_f32_dpp v36, v30, v36 quad_perm:[2,2,2,2] row_mask:0xf bank_mask:0xf
    v_add_f32_dpp v37, v34, v37 quad_perm:[2,2,2,2] row_mask:0xf bank_mask:0xf
    s_nop 0
    v_add_f32_dpp v36, v31, v36 quad_perm:[3,3,3,3] row_mask:0xf bank_mask:0xf
    v_add_f32_dpp v37, v35, v37 quad_perm:[3,3,3,3] row_mask:0xf bank_mask:0xf
    v_cvt_pk_bf16_f32 v38, v36, v37
    v_min_u32 v38, -2, v38
    ds_write_b32 v53, v38 offset:20228
    s_waitcnt vmcnt(20)
    v_mfma_f32_16x16x32_bf16 v[28:31], v[192:195], v[8:11], 0
    v_mfma_f32_16x16x32_bf16 v[32:35], v[200:203], v[8:11], 0
    v_mfma_f32_16x16x32_bf16 v[28:31], v[196:199], v[12:15], v[28:31]
    v_mfma_f32_16x16x32_bf16 v[32:35], v[204:207], v[12:15], v[32:35]
    s_nop 6
    v_mov_b32_dpp v36, v28 quad_perm:[0,0,0,0] row_mask:0xf bank_mask:0xf
    v_mov_b32_dpp v37, v32 quad_perm:[0,0,0,0] row_mask:0xf bank_mask:0xf
    s_nop 0
    v_add_f32_dpp v36, v29, v36 quad_perm:[1,1,1,1] row_mask:0xf bank_mask:0xf
    v_add_f32_dpp v37, v33, v37 quad_perm:[1,1,1,1] row_mask:0xf bank_mask:0xf
    s_nop 0
    v_add_f32_dpp v36, v30, v36 quad_perm:[2,2,2,2] row_mask:0xf bank_mask:0xf
    v_add_f32_dpp v37, v34, v37 quad_perm:[2,2,2,2] row_mask:0xf bank_mask:0xf
    s_nop 0
    v_add_f32_dpp v36, v31, v36 quad_perm:[3,3,3,3] row_mask:0xf bank_mask:0xf
    v_add_f32_dpp v37, v35, v37 quad_perm:[3,3,3,3] row_mask:0xf bank_mask:0xf
    v_cvt_pk_bf16_f32 v38, v36, v37
    v_min_u32 v38, -2, v38
    ds_write_b32 v53, v38 offset:20480
    s_waitcnt vmcnt(16)
    v_mfma_f32_16x16x32_bf16 v[28:31], v[208:211], v[8:11], 0
    v_mfma_f32_16x16x32_bf16 v[32:35], v[216:219], v[8:11], 0
    v_mfma_f32_16x16x32_bf16 v[28:31], v[212:215], v[12:15], v[28:31]
    v_mfma_f32_16x16x32_bf16 v[32:35], v[220:223], v[12:15], v[32:35]
    s_nop 6
    v_mov_b32_dpp v36, v28 quad_perm:[0,0,0,0] row_mask:0xf bank_mask:0xf
    v_mov_b32_dpp v37, v32 quad_perm:[0,0,0,0] row_mask:0xf bank_mask:0xf
    s_nop 0
    v_add_f32_dpp v36, v29, v36 quad_perm:[1,1,1,1] row_mask:0xf bank_mask:0xf
    v_add_f32_dpp v37, v33, v37 quad_perm:[1,1,1,1] row_mask:0xf bank_mask:0xf
    s_nop 0
    v_add_f32_dpp v36, v30, v36 quad_perm:[2,2,2,2] row_mask:0xf bank_mask:0xf
    v_add_f32_dpp v37, v34, v37 quad_perm:[2,2,2,2] row_mask:0xf bank_mask:0xf
    s_nop 0
    v_add_f32_dpp v36, v31, v36 quad_perm:[3,3,3,3] row_mask:0xf bank_mask:0xf
    v_add_f32_dpp v37, v35, v37 quad_perm:[3,3,3,3] row_mask:0xf bank_mask:0xf
    v_cvt_pk_bf16_f32 v38, v36, v37
    v_min_u32 v38, -2, v38
    ds_write_b32 v53, v38 offset:20484
    s_waitcnt vmcnt(12)
    v_mfma_f32_16x16x32_bf16 v[28:31], v[224:227], v[8:11], 0
    v_mfma_f32_16x16x32_bf16 v[32:35], v[232:235], v[8:11], 0
    v_mfma_f32_16x16x32_bf16 v[28:31], v[228:231], v[12:15], v[28:31]
    v_mfma_f32_16x16x32_bf16 v[32:35], v[236:239], v[12:15], v[32:35]
    s_nop 6
    v_mov_b32_dpp v36, v28 quad_perm:[0,0,0,0] row_mask:0xf bank_mask:0xf
    v_mov_b32_dpp v37, v32 quad_perm:[0,0,0,0] row_mask:0xf bank_mask:0xf
    s_nop 0
    v_add_f32_dpp v36, v29, v36 quad_perm:[1,1,1,1] row_mask:0xf bank_mask:0xf
    v_add_f32_dpp v37, v33, v37 quad_perm:[1,1,1,1] row_mask:0xf bank_mask:0xf
    s_nop 0
    v_add_f32_dpp v36, v30, v36 quad_perm:[2,2,2,2] row_mask:0xf bank_mask:0xf
    v_add_f32_dpp v37, v34, v37 quad_perm:[2,2,2,2] row_mask:0xf bank_mask:0xf
    s_nop 0
    v_add_f32_dpp v36, v31, v36 quad_perm:[3,3,3,3] row_mask:0xf bank_mask:0xf
    v_add_f32_dpp v37, v35, v37 quad_perm:[3,3,3,3] row_mask:0xf bank_mask:0xf
    v_cvt_pk_bf16_f32 v38, v36, v37
    v_min_u32 v38, -2, v38
    ds_write_b32 v53, v38 offset:20736
    s_waitcnt vmcnt(8)
    v_mfma_f32_16x16x32_bf16 v[28:31], v[240:243], v[8:11], 0
    v_mfma_f32_16x16x32_bf16 v[32:35], v[248:251], v[8:11], 0
    v_mfma_f32_16x16x32_bf16 v[28:31], v[244:247], v[12:15], v[28:31]
    v_mfma_f32_16x16x32_bf16 v[32:35], v[252:255], v[12:15], v[32:35]
    s_nop 6
    v_mov_b32_dpp v36, v28 quad_perm:[0,0,0,0] row_mask:0xf bank_mask:0xf
    v_mov_b32_dpp v37, v32 quad_perm:[0,0,0,0] row_mask:0xf bank_mask:0xf
    s_nop 0
    v_add_f32_dpp v36, v29, v36 quad_perm:[1,1,1,1] row_mask:0xf bank_mask:0xf
    v_add_f32_dpp v37, v33, v37 quad_perm:[1,1,1,1] row_mask:0xf bank_mask:0xf
    s_nop 0
    v_add_f32_dpp v36, v30, v36 quad_perm:[2,2,2,2] row_mask:0xf bank_mask:0xf
    v_add_f32_dpp v37, v34, v37 quad_perm:[2,2,2,2] row_mask:0xf bank_mask:0xf
    s_nop 0
    v_add_f32_dpp v36, v31, v36 quad_perm:[3,3,3,3] row_mask:0xf bank_mask:0xf
    v_add_f32_dpp v37, v35, v37 quad_perm:[3,3,3,3] row_mask:0xf bank_mask:0xf
    v_cvt_pk_bf16_f32 v38, v36, v37
    v_min_u32 v38, -2, v38
    ds_write_b32 v53, v38 offset:20740
L_loopK:
    v_add_u32 v53, s65, v61
    s_waitcnt vmcnt(4)
    v_mfma_f32_16x16x32_bf16 v[28:31], v[64:67], v[8:11], 0
    v_mfma_f32_16x16x32_bf16 v[32:35], v[72:75], v[8:11], 0
    v_mfma_f32_16x16x32_bf16 v[28:31], v[68:71], v[12:15], v[28:31]
    v_mfma_f32_16x16x32_bf16 v[32:35], v[76:79], v[12:15], v[32:35]
    s_call_b64 s[60:61], L_next
    s_mov_b32 s64, s59
    s_lshl_b32 s68, s59, 13
    buffer_load_dwordx4 v[64:67], v2, s[36:39], s68 offen offset:0 nt
    buffer_load_dwordx4 v[68:71], v2, s[36:39], s68 offen offset:256 nt
    buffer_load_dwordx4 v[72:75], v2, s[36:39], s68 offen offset:2048 nt
    buffer_load_dwordx4 v[76:79], v2, s[36:39], s68 offen offset:2304 nt
    v_mov_b32_dpp v36, v28 quad_perm:[0,0,0,0] row_mask:0xf bank_mask:0xf
    v_mov_b32_dpp v37, v32 quad_perm:[0,0,0,0] row_mask:0xf bank_mask:0xf
    s_nop 0
    v_add_f32_dpp v36, v29, v36 quad_perm:[1,1,1,1] row_mask:0xf bank_mask:0xf
    v_add_f32_dpp v37, v33, v37 quad_perm:[1,1,1,1] row_mask:0xf bank_mask:0xf
    s_nop 0
    v_add_f32_dpp v36, v30, v36 quad_perm:[2,2,2,2] row_mask:0xf bank_mask:0xf
    v_add_f32_dpp v37, v34, v37 quad_perm:[2,2,2,2] row_mask:0xf bank_mask:0xf
    s_nop 0
    v_add_f32_dpp v36, v31, v36 quad_perm:[3,3,3,3] row_mask:0xf bank_mask:0xf
    v_add_f32_dpp v37, v35, v37 quad_perm:[3,3,3,3] row_mask:0xf bank_mask:0xf
    v_cvt_pk_bf16_f32 v38, v36, v37
    v_min_u32 v38, -2, v38
    ds_write_b32 v53, v38 offset:0
    s_waitcnt vmcnt(4)
    v_mfma_f32_16x16x32_bf16 v[28:31], v[80:83], v[8:11], 0
    v_mfma_f32_16x16x32_bf16 v[32:35], v[88:91], v[8:11], 0
    v_mfma_f32_16x16x32_bf16 v[28:31], v[84:87], v[12:15], v[28:31]
    v_mfma_f32_16x16x32_bf16 v[32:35], v[92:95], v[12:15], v[32:35]
    buffer_load_dwordx4 v[80:83], v60, s[36:39], s68 offen offset:0 nt
    buffer_load_dwordx4 v[84:87], v60, s[36:39], s68 offen offset:256 nt
    buffer_load_dwordx4 v[88:91], v60, s[36:39], s68 offen offset:2048 nt
    buffer_load_dwordx4 v[92:95], v60, s[36:39], s68 offen offset:2304 nt
    s_nop 2
    v_mov_b32_dpp v36, v28 quad_perm:[0,0,0,0] row_mask:0xf bank_mask:0xf
    v_mov_b32_dpp v37, v32 quad_perm:[0,0,0,0] row_mask:0xf bank_mask:0xf
    s_nop 0
    v_add_f32_dpp v36, v29, v36 quad_perm:[1,1,1,1] row_mask:0xf bank_mask:0xf
    v_add_f32_dpp v37, v33, v37 quad_perm:[1,1,1,1] row_mask:0xf bank_mask:0xf
    s_nop 0
    v_add_f32_dpp v36, v30, v36 quad_perm:[2,2,2,2] row_mask:0xf bank_mask:0xf
    v_add_f32_dpp v37, v34, v37 quad_perm:[2,2,2,2] row_mask:0xf bank_mask:0xf
    s_nop 0
    v_add_f32_dpp v36, v31, v36 quad_perm:[3,3,3,3] row_mask:0xf bank_mask:0xf
    v_add_f32_dpp v37, v35, v37 quad_perm:[3,3,3,3] row_mask:0xf bank_mask:0xf
    v_cvt_pk_bf16_f32 v38, v36, v37
    v_min_u32 v38, -2, v38
    ds_write_b32 v53, v38 offset:4
    s_cmp_eq_u32 s56, 0
    s_cbranch_scc1 L_loopK
    s_waitcnt lgkmcnt(0)
    s_mov_b64 exec, 1
    ds_add_u32 v57, v59 offset:20
    s_mov_b64 exec, -1
    s_lshl_b32 s58, s28, 11
    v_add_u32 v100, s58, v27
    s_lshl_b32 s58, s28, 10
    v_add_u32 v101, s58, v27
    v_lshrrev_b32 v103, 5, v0
    v_lshlrev_b32 v103, 3, v103
    v_bfe_u32 v102, v0, 2, 2
    v_add_u32 v102, v102, v103
    v_lshlrev_b32 v102, 11, v102
    v_and_b32 v103, 3, v0
    v_lshlrev_b32 v103, 5, v103
    v_and_b32 v104, 16, v0
    v_add3_u32 v102, v102, v103, v104
    s_lshl_b32 s70, s29, 15
    s_lshl_b32 s58, s28, 13
    s_add_u32 s70, s70, s58
    s_lshl_b32 s58, s30, 7
    s_add_u32 s70, s70, s58
    s_add_u32 s70, s70, 1048576
    v_mov_b32 v105, 32
    s_branch L_loopV
L_rescale:
    s_nop 7
    v_mov_b32 v54, v41
    s_nop 1
    v_permlane16_swap_b32 v54, v41
    v_max_f32 v41, v54, v41
    v_mov_b32 v54, v41
    s_nop 1
    v_permlane32_swap_b32 v54, v41
    v_max_f32 v41, v54, v41
    v_max_f32 v41, v41, v24
    v_sub_f32 v54, v24, v41
    v_mul_f32 v54, s62, v54
    v_exp_f32 v54, v54
    v_mov_b32 v24, v41
L_scaleO:
    v_readlane_b32 s58, v54, 0
    v_readlane_b32 s59, v54, 8
    s_nop 0
    v_mov_b32 v55, s58
    v_mov_b32 v54, s59
    v_cndmask_b32 v55, v54, v55, s[72:73]
    v_mul_f32 v16, v16, v55
    v_mul_f32 v17, v17, v55
    v_mul_f32 v18, v18, v55
    v_mul_f32 v19, v19, v55
    v_mul_f32 v20, v20, v55
    v_mul_f32 v21, v21, v55
    v_mul_f32 v22, v22, v55
    v_mul_f32 v23, v23, v55
    s_nop 3
    s_setpc_b64 s[60:61]
L_apply:
    v_and_b32 v54, 8, v0
    ds_read_b64 v[32:33], v54 offset:32
    s_mov_b32 s35, 1
    s_waitcnt lgkmcnt(0)
    v_sub_f32 v54, v24, v32
    v_fma_f32 v54, v54, s62, v33
    v_exp_f32 v54, v54
    v_mov_b32 v24, v32
    v_mov_b32 v26, v33
    s_nop 4
    s_branch L_scaleO
L_v_reread:
    ds_read_b64 v[62:63], v1
    s_sub_u32 s76, s76, 1
    s_cmp_eq_u32 s76, 0
    s_cbranch_scc1 L_v_go
    s_branch L_v_chk
L_loopV:
    s_cmp_ge_u32 s64, 2048
    s_cbranch_scc1 L_sdone
    s_mov_b32 s76, 400000
L_v_chk:
    s_waitcnt lgkmcnt(0)
    v_max_u32 v30, v62, v63
    v_cmp_eq_u32 vcc, -1, v30
    s_cbranch_vccnz L_v_reread
L_v_go:
    v_mov_b32 v30, v62
    v_mov_b32 v31, v63
    v_readfirstlane_b32 s58, v25
    s_nop 0
    s_cmp_le_u32 s58, s35
    s_cbranch_scc1 L_v_na
    s_call_b64 s[60:61], L_apply
L_v_na:
    v_lshlrev_b32 v39, 16, v30
    v_and_b32 v40, 0xffff0000, v30
    v_max_f32 v41, v39, v40
    v_cmp_gt_f32 vcc, v41, v24
    s_cbranch_vccz L_nors_47
    s_call_b64 s[60:61], L_rescale
L_nors_47:
    v_sub_f32 v42, v39, v24
    v_sub_f32 v43, v40, v24
    v_fma_f32 v42, v42, s62, v26
    v_fma_f32 v43, v43, s62, v26
    v_exp_f32 v42, v42
    v_exp_f32 v43, v43
    v_cvt_pk_bf16_f32 v52, v42, v42
    v_cvt_pk_bf16_f32 v53, v43, v43
    v_and_b32 v44, v52, v4
    v_and_b32 v45, v52, v5
    v_and_b32 v46, v52, v6
    v_and_b32 v47, v52, v7
    v_and_b32 v48, v53, v4
    v_and_b32 v49, v53, v5
    v_and_b32 v50, v53, v6
    v_and_b32 v51, v53, v7
    s_waitcnt vmcnt(4)
    v_mfma_f32_16x16x32_bf16 v[16:19], v[44:47], v[64:67], v[16:19]
    v_mfma_f32_16x16x32_bf16 v[20:23], v[44:47], v[68:71], v[20:23]
    v_mfma_f32_16x16x32_bf16 v[16:19], v[48:51], v[72:75], v[16:19]
    v_mfma_f32_16x16x32_bf16 v[20:23], v[48:51], v[76:79], v[20:23]
    s_call_b64 s[60:61], L_next
    s_mov_b32 s64, s59
    s_lshl_b32 s68, s59, 13
    s_cmp_lt_u32 s64, 2048
    s_cbranch_scc1 L_ld_48
    s_add_u32 s77, s77, 1
    s_nop 3
    s_branch L_ldd_49
L_ld_48:
    buffer_load_dwordx4 v[64:67], v2, s[36:39], s68 offen offset:0 nt
    buffer_load_dwordx4 v[68:71], v2, s[36:39], s68 offen offset:256 nt
    buffer_load_dwordx4 v[72:75], v2, s[36:39], s68 offen offset:2048 nt
    buffer_load_dwordx4 v[76:79], v2, s[36:39], s68 offen offset:2304 nt
L_ldd_49:
    v_lshlrev_b32 v39, 16, v31
    v_and_b32 v40, 0xffff0000, v31
    v_max_f32 v41, v39, v40
    v_cmp_gt_f32 vcc, v41, v24
    s_cbranch_vccz L_nors_50
    s_call_b64 s[60:61], L_rescale
L_nors_50:
    v_sub_f32 v42, v39, v24
    v_sub_f32 v43, v40, v24
    v_fma_f32 v42, v42, s62, v26
    v_fma_f32 v43, v43, s62, v26
    v_exp_f32 v42, v42
    v_exp_f32 v43, v43
    v_cvt_pk_bf16_f32 v52, v42, v42
    v_cvt_pk_bf16_f32 v53, v43, v43
    v_and_b32 v44, v52, v4
    v_and_b32 v45, v52, v5
    v_and_b32 v46, v52, v6
    v_and_b32 v47, v52, v7
    v_and_b32 v48, v53, v4
    v_and_b32 v49, v53, v5
    v_and_b32 v50, v53, v6
    v_and_b32 v51, v53, v7
    s_waitcnt vmcnt(4)
    s_cmp_eq_u32 s77, 0
    s_cbranch_scc1 L_w_51
    s_waitcnt vmcnt(0)
L_w_51:
    v_mfma_f32_16x16x32_bf16 v[16:19], v[44:47], v[80:83], v[16:19]
    v_mfma_f32_16x16x32_bf16 v[20:23], v[44:47], v[84:87], v[20:23]
    v_mfma_f32_16x16x32_bf16 v[16:19], v[48:51], v[88:91], v[16:19]
    v_mfma_f32_16x16x32_bf16 v[20:23], v[48:51], v[92:95], v[20:23]
    s_cmp_lt_u32 s64, 2048
    s_cbranch_scc1 L_ld_52
    s_add_u32 s77, s77, 1
    s_nop 3
    s_branch L_ldd_53
L_ld_52:
    buffer_load_dwordx4 v[80:83], v60, s[36:39], s68 offen offset:0 nt
    buffer_load_dwordx4 v[84:87], v60, s[36:39], s68 offen offset:256 nt
    buffer_load_dwordx4 v[88:91], v60, s[36:39], s68 offen offset:2048 nt
    buffer_load_dwordx4 v[92:95], v60, s[36:39], s68 offen offset:2304 nt
L_ldd_53:
    s_branch L_loopV
L_sdone:
    s_waitcnt vmcnt(0)
    s_nop 7
    s_cmp_lg_u32 s35, 0
    s_cbranch_scc1 L_sd_ok
    s_mov_b32 s76, 400000
L_lw_54:
    ds_read_b32 v54, v57 offset:24
    s_waitcnt lgkmcnt(0)
    v_readfirstlane_b32 s58, v54
    s_nop 0
    s_cmp_lg_u32 s58, 0
    s_cbranch_scc1 L_lwd_55
    s_sleep 2
    s_sub_u32 s76, s76, 1
    s_cmp_gt_i32 s76, 0
    s_cbranch_scc1 L_lw_54
L_lwd_55:
    s_call_b64 s[60:61], L_apply
L_sd_ok:
    ds_write_b128 v100, v[16:19] offset:6144
    ds_write_b128 v100, v[20:23] offset:7168
    s_waitcnt lgkmcnt(0)
    s_barrier
    s_cmp_ge_u32 s28, 2
    s_cbranch_scc1 L_w23
    ds_read_b128 v[72:75], v101 offset:6144
    ds_read_b128 v[76:79], v101 offset:8192
    ds_read_b128 v[80:83], v101 offset:10240
    ds_read_b128 v[84:87], v101 offset:12288
    s_waitcnt lgkmcnt(2)
    v_add_f32 v96, v72, v76
    v_add_f32 v97, v73, v77
    v_add_f32 v98, v74, v78
    v_add_f32 v99, v75, v79
    s_waitcnt lgkmcnt(0)
    v_add_f32 v80, v80, v84
    v_add_f32 v81, v81, v85
    v_add_f32 v82, v82, v86
    v_add_f32 v83, v83, v87
    v_add_f32 v96, v96, v80
    v_add_f32 v97, v97, v81
    v_add_f32 v98, v98, v82
    v_add_f32 v99, v99, v83
    v_min_u32 v96, -2, v96
    v_min_u32 v97, -2, v97
    v_min_u32 v98, -2, v98
    v_min_u32 v99, -2, v99
    buffer_store_dwordx4 v[96:99], v102, s[44:47], s70 offen sc1
    s_mov_b64 exec, 1
    ds_add_u32 v57, v105 offset:12
    s_mov_b64 exec, -1
    s_branch L_exit
L_w23:
    s_cmp_lg_u32 s28, 2
    s_cbranch_scc1 L_exit
    v_mov_b32 v8, 0
    v_mov_b32 v9, 0x7fffff00
    s_branch L_tailw
L_hw0:
    s_mov_b32 s74, 0x01000100
    s_mov_b32 s75, 0x03020302
    v_mov_b32 v8, 0
    v_and_b32 v1, 1, v0
    v_lshlrev_b32 v1, 4, v1
    v_mov_b32 v52, 0xffff
    v_lshlrev_b32 v52, v1, v52
    v_bfe_u32 v1, v0, 1, 2
    v_cmp_eq_u32 vcc, 0, v1
    s_nop 1
    v_cndmask_b32 v4, 0, v52, vcc
    v_cmp_eq_u32 vcc, 1, v1
    s_nop 1
    v_cndmask_b32 v5, 0, v52, vcc
    v_cmp_eq_u32 vcc, 2, v1
    s_nop 1
    v_cndmask_b32 v6, 0, v52, vcc
    v_cmp_eq_u32 vcc, 3, v1
    s_nop 1
    v_cndmask_b32 v7, 0, v52, vcc
    s_mov_b32 s59, 0
    s_barrier
    s_waitcnt vmcnt(23)
    v_lshlrev_b32 v192, 16, v16
    v_and_b32 v193, 0xffff0000, v16
    v_lshlrev_b32 v194, 16, v17
    v_and_b32 v195, 0xffff0000, v17
    v_lshlrev_b32 v196, 16, v18
    v_and_b32 v197, 0xffff0000, v18
    v_lshlrev_b32 v198, 16, v19
    v_and_b32 v199, 0xffff0000, v19
    v_lshlrev_b32 v200, 16, v20
    v_and_b32 v201, 0xffff0000, v20
    v_lshlrev_b32 v202, 16, v21
    v_and_b32 v203, 0xffff0000, v21
    v_lshlrev_b32 v204, 16, v22
    v_and_b32 v205, 0xffff0000, v22
    v_add_f32 v24, v192, v193
    v_add_f32 v25, v194, v195
    v_add_f32 v24, v24, v196
    v_add_f32 v25, v25, v197
    v_add_f32 v24, v24, v198
    v_add_f32 v25, v25, v199
    v_add_f32 v24, v24, v200
    v_add_f32 v25, v25, v201
    v_add_f32 v24, v24, v202
    v_add_f32 v25, v25, v203
    v_add_f32 v24, v24, v204
    v_add_f32 v25, v25, v205
    v_add_f32 v24, v24, v25
    s_nop 1
    v_add_f32_dpp v24, v24, v24 row_ror:8 row_mask:0xf bank_mask:0xf
    s_nop 1
    v_add_f32_dpp v24, v24, v24 row_ror:4 row_mask:0xf bank_mask:0xf
    s_nop 1
    v_add_f32_dpp v24, v24, v24 row_ror:2 row_mask:0xf bank_mask:0xf
    v_mov_b32 v28, v24
    s_nop 1
    v_permlane16_swap_b32 v28, v24
    v_add_f32 v24, v28, v24
    v_mov_b32 v28, v24
    s_nop 1
    v_permlane32_swap_b32 v28, v24
    v_add_f32 v24, v28, v24
    s_mov_b32 s58, 0x3b124925
    v_mul_f32 v24, s58, v24
    v_sub_f32 v28, v192, v24
    v_sub_f32 v29, v193, v24
    v_mul_f32 v25, v28, v28
    v_mul_f32 v26, v29, v29
    v_sub_f32 v28, v194, v24
    v_sub_f32 v29, v195, v24
    v_fmac_f32 v25, v28, v28
    v_fmac_f32 v26, v29, v29
    v_sub_f32 v28, v196, v24
    v_sub_f32 v29, v197, v24
    v_fmac_f32 v25, v28, v28
    v_fmac_f32 v26, v29, v29
    v_sub_f32 v28, v198, v24
    v_sub_f32 v29, v199, v24
    v_fmac_f32 v25, v28, v28
    v_fmac_f32 v26, v29, v29
    v_sub_f32 v28, v200, v24
    v_sub_f32 v29, v201, v24
    v_fmac_f32 v25, v28, v28
    v_fmac_f32 v26, v29, v29
    v_sub_f32 v28, v202, v24
    v_sub_f32 v29, v203, v24
    v_fmac_f32 v25, v28, v28
    v_fmac_f32 v26, v29, v29
    v_sub_f32 v28, v204, v24
    v_sub_f32 v29, v205, v24
    v_fmac_f32 v25, v28, v28
    v_fmac_f32 v26, v29, v29
    v_add_f32 v25, v25, v26
    s_nop 1
    v_add_f32_dpp v25, v25, v25 row_ror:8 row_mask:0xf bank_mask:0xf
    s_nop 1
    v_add_f32_dpp v25, v25, v25 row_ror:4 row_mask:0xf bank_mask:0xf
    s_nop 1
    v_add_f32_dpp v25, v25, v25 row_ror:2 row_mask:0xf bank_mask:0xf
    v_mov_b32 v28, v25
    s_nop 1
    v_permlane16_swap_b32 v28, v25
    v_add_f32 v25, v28, v25
    v_mov_b32 v28, v25
    s_nop 1
    v_permlane32_swap_b32 v28, v25
    v_add_f32 v25, v28, v25
    v_mul_f32 v25, s58, v25
    v_cvt_pk_bf16_f32 v26, v24, v25
    v_lshlrev_b32 v24, 16, v26
    v_and_b32 v25, 0xffff0000, v26
    v_add_f32 v25, 0x3727c5ac, v25
    v_cvt_pk_bf16_f32 v25, v25, v25
    v_and_b32 v25, 0xffff0000, v25
    v_sqrt_f32 v25, v25
    s_nop 0
    v_cvt_pk_bf16_f32 v25, v25, v25
    v_and_b32 v25, 0xffff0000, v25
    v_rcp_f32 v26, v25
    v_sub_f32 v192, v192, v24
    v_sub_f32 v193, v193, v24
    v_cvt_pk_bf16_f32 v28, v192, v193
    v_lshlrev_b32 v192, 16, v28
    v_and_b32 v193, 0xffff0000, v28
    v_mul_f32 v28, v192, v26
    v_mul_f32 v29, v193, v26
    v_fma_f32 v192, -v28, v25, v192
    v_fma_f32 v193, -v29, v25, v193
    v_fmac_f32 v28, v192, v26
    v_fmac_f32 v29, v193, v26
    v_cvt_pk_bf16_f32 v16, v28, v29
    v_sub_f32 v194, v194, v24
    v_sub_f32 v195, v195, v24
    v_cvt_pk_bf16_f32 v28, v194, v195
    v_lshlrev_b32 v194, 16, v28
    v_and_b32 v195, 0xffff0000, v28
    v_mul_f32 v28, v194, v26
    v_mul_f32 v29, v195, v26
    v_fma_f32 v194, -v28, v25, v194
    v_fma_f32 v195, -v29, v25, v195
    v_fmac_f32 v28, v194, v26
    v_fmac_f32 v29, v195, v26
    v_cvt_pk_bf16_f32 v17, v28, v29
    v_sub_f32 v196, v196, v24
    v_sub_f32 v197, v197, v24
    v_cvt_pk_bf16_f32 v28, v196, v197
    v_lshlrev_b32 v196, 16, v28
    v_and_b32 v197, 0xffff0000, v28
    v_mul_f32 v28, v196, v26
    v_mul_f32 v29, v197, v26
    v_fma_f32 v196, -v28, v25, v196
    v_fma_f32 v197, -v29, v25, v197
    v_fmac_f32 v28, v196, v26
    v_fmac_f32 v29, v197, v26
    v_cvt_pk_bf16_f32 v18, v28, v29
    v_sub_f32 v198, v198, v24
    v_sub_f32 v199, v199, v24
    v_cvt_pk_bf16_f32 v28, v198, v199
    v_lshlrev_b32 v198, 16, v28
    v_and_b32 v199, 0xffff0000, v28
    v_mul_f32 v28, v198, v26
    v_mul_f32 v29, v199, v26
    v_fma_f32 v198, -v28, v25, v198
    v_fma_f32 v199, -v29, v25, v199
    v_fmac_f32 v28, v198, v26
    v_fmac_f32 v29, v199, v26
    v_cvt_pk_bf16_f32 v19, v28, v29
    v_sub_f32 v200, v200, v24
    v_sub_f32 v201, v201, v24
    v_cvt_pk_bf16_f32 v28, v200, v201
    v_lshlrev_b32 v200, 16, v28
    v_and_b32 v201, 0xffff0000, v28
    v_mul_f32 v28, v200, v26
    v_mul_f32 v29, v201, v26
    v_fma_f32 v200, -v28, v25, v200
    v_fma_f32 v201, -v29, v25, v201
    v_fmac_f32 v28, v200, v26
    v_fmac_f32 v29, v201, v26
    v_cvt_pk_bf16_f32 v20, v28, v29
    v_sub_f32 v202, v202, v24
    v_sub_f32 v203, v203, v24
    v_cvt_pk_bf16_f32 v28, v202, v203
    v_lshlrev_b32 v202, 16, v28
    v_and_b32 v203, 0xffff0000, v28
    v_mul_f32 v28, v202, v26
    v_mul_f32 v29, v203, v26
    v_fma_f32 v202, -v28, v25, v202
    v_fma_f32 v203, -v29, v25, v203
    v_fmac_f32 v28, v202, v26
    v_fmac_f32 v29, v203, v26
    v_cvt_pk_bf16_f32 v21, v28, v29
    v_sub_f32 v204, v204, v24
    v_sub_f32 v205, v205, v24
    v_cvt_pk_bf16_f32 v28, v204, v205
    v_lshlrev_b32 v204, 16, v28
    v_and_b32 v205, 0xffff0000, v28
    v_mul_f32 v28, v204, v26
    v_mul_f32 v29, v205, v26
    v_fma_f32 v204, -v28, v25, v204
    v_fma_f32 v205, -v29, v25, v205
    v_fmac_f32 v28, v204, v26
    v_fmac_f32 v29, v205, v26
    v_cvt_pk_bf16_f32 v22, v28, v29
    v_lshrrev_b32 v28, 1, v0
    v_mul_u32_u24 v28, 28, v28
    v_and_b32 v29, 1, v0
    v_lshlrev_b32 v29, 10, v29
    v_add3_u32 v28, v28, v29, s59
    ds_write_b32 v28, v16 offset:2048
    ds_write_b32 v28, v17 offset:2052
    ds_write_b32 v28, v18 offset:2056
    ds_write_b32 v28, v19 offset:2060
    ds_write_b32 v28, v20 offset:2064
    ds_write_b32 v28, v21 offset:2068
    ds_write_b32 v28, v22 offset:2072
    v_bfe_u32 v11, v0, 3, 1
    v_lshlrev_b32 v11, 10, v11
    v_lshrrev_b32 v29, 4, v0
    v_mul_u32_u24 v29, 56, v29
    v_add3_u32 v11, v11, v29, s59
    s_waitcnt lgkmcnt(0)
    s_mul_i32 s58, s65, 224
    v_add_u32 v11, s58, v11
    ds_read_b64 v[32:33], v11 offset:2048
    ds_read_b64 v[34:35], v11 offset:2056
    ds_read_b64 v[36:37], v11 offset:2064
    ds_read_b64 v[38:39], v11 offset:2072
    ds_read_b64 v[40:41], v11 offset:2080
    ds_read_b64 v[42:43], v11 offset:2088
    ds_read_b64 v[44:45], v11 offset:2096
    s_waitcnt lgkmcnt(0)
    v_perm_b32 v52, v32, v32, s74
    v_and_b32 v48, v52, v4
    v_and_b32 v49, v52, v5
    v_and_b32 v50, v52, v6
    v_and_b32 v51, v52, v7
    s_waitcnt vmcnt(13)
    s_nop 0
    v_mfma_f32_16x16x32_bf16 v[12:15], v[48:51], v[64:67], 0
    v_perm_b32 v60, v39, v39, s74
    v_and_b32 v56, v60, v4
    v_and_b32 v57, v60, v5
    v_and_b32 v58, v60, v6
    v_and_b32 v59, v60, v7
    s_nop 1
    v_mfma_f32_16x16x32_bf16 v[16:19], v[56:59], v[64:67], 0
    v_perm_b32 v52, v32, v32, s75
    v_and_b32 v48, v52, v4
    v_and_b32 v49, v52, v5
    v_and_b32 v50, v52, v6
    v_and_b32 v51, v52, v7
    s_nop 1
    v_mfma_f32_16x16x32_bf16 v[12:15], v[48:51], v[68:71], v[12:15]
    v_perm_b32 v60, v39, v39, s75
    v_and_b32 v56, v60, v4
    v_and_b32 v57, v60, v5
    v_and_b32 v58, v60, v6
    v_and_b32 v59, v60, v7
    s_nop 1
    v_mfma_f32_16x16x32_bf16 v[16:19], v[56:59], v[68:71], v[16:19]
    v_perm_b32 v52, v33, v33, s74
    v_and_b32 v48, v52, v4
    v_and_b32 v49, v52, v5
    v_and_b32 v50, v52, v6
    v_and_b32 v51, v52, v7
    s_waitcnt vmcnt(11)
    s_nop 0
    v_mfma_f32_16x16x32_bf16 v[12:15], v[48:51], v[72:75], v[12:15]
    v_perm_b32 v60, v40, v40, s74
    v_and_b32 v56, v60, v4
    v_and_b32 v57, v60, v5
    v_and_b32 v58, v60, v6
    v_and_b32 v59, v60, v7
    s_nop 1
    v_mfma_f32_16x16x32_bf16 v[16:19], v[56:59], v[72:75], v[16:19]
    v_perm_b32 v52, v33, v33, s75
    v_and_b32 v48, v52, v4
    v_and_b32 v49, v52, v5
    v_and_b32 v50, v52, v6
    v_and_b32 v51, v52, v7
    s_nop 1
    v_mfma_f32_16x16x32_bf16 v[12:15], v[48:51], v[76:79], v[12:15]
    v_perm_b32 v60, v40, v40, s75
    v_and_b32 v56, v60, v4
    v_and_b32 v57, v60, v5
    v_and_b32 v58, v60, v6
    v_and_b32 v59, v60, v7
    s_nop 1
    v_mfma_f32_16x16x32_bf16 v[16:19], v[56:59], v[76:79], v[16:19]
    v_perm_b32 v52, v34, v34, s74
    v_and_b32 v48, v52, v4
    v_and_b32 v49, v52, v5
    v_and_b32 v50, v52, v6
    v_and_b32 v51, v52, v7
    s_waitcnt vmcnt(9)
    s_nop 0
    v_mfma_f32_16x16x32_bf16 v[12:15], v[48:51], v[80:83], v[12:15]
    v_perm_b32 v60, v41, v41, s74
    v_and_b32 v56, v60, v4
    v_and_b32 v57, v60, v5
    v_and_b32 v58, v60, v6
    v_and_b32 v59, v60, v7
    s_nop 1
    v_mfma_f32_16x16x32_bf16 v[16:19], v[56:59], v[80:83], v[16:19]
    v_perm_b32 v52, v34, v34, s75
    v_and_b32 v48, v52, v4
    v_and_b32 v49, v52, v5
    v_and_b32 v50, v52, v6
    v_and_b32 v51, v52, v7
    s_nop 1
    v_mfma_f32_16x16x32_bf16 v[12:15], v[48:51], v[84:87], v[12:15]
    v_perm_b32 v60, v41, v41, s75
    v_and_b32 v56, v60, v4
    v_and_b32 v57, v60, v5
    v_and_b32 v58, v60, v6
    v_and_b32 v59, v60, v7
    s_nop 1
    v_mfma_f32_16x16x32_bf16 v[16:19], v[56:59], v[84:87], v[16:19]
    v_perm_b32 v52, v35, v35, s74
    v_and_b32 v48, v52, v4
    v_and_b32 v49, v52, v5
    v_and_b32 v50, v52, v6
    v_and_b32 v51, v52, v7
    s_waitcnt vmcnt(7)
    s_nop 0
    v_mfma_f32_16x16x32_bf16 v[12:15], v[48:51], v[88:91], v[12:15]
    v_perm_b32 v60, v42, v42, s74
    v_and_b32 v56, v60, v4
    v_and_b32 v57, v60, v5
    v_and_b32 v58, v60, v6
    v_and_b32 v59, v60, v7
    s_nop 1
    v_mfma_f32_16x16x32_bf16 v[16:19], v[56:59], v[88:91], v[16:19]
    v_perm_b32 v52, v35, v35, s75
    v_and_b32 v48, v52, v4
    v_and_b32 v49, v52, v5
    v_and_b32 v50, v52, v6
    v_and_b32 v51, v52, v7
    s_nop 1
    v_mfma_f32_16x16x32_bf16 v[12:15], v[48:51], v[92:95], v[12:15]
    v_perm_b32 v60, v42, v42, s75
    v_and_b32 v56, v60, v4
    v_and_b32 v57, v60, v5
    v_and_b32 v58, v60, v6
    v_and_b32 v59, v60, v7
    s_nop 1
    v_mfma_f32_16x16x32_bf16 v[16:19], v[56:59], v[92:95], v[16:19]
    v_perm_b32 v52, v36, v36, s74
    v_and_b32 v48, v52, v4
    v_and_b32 v49, v52, v5
    v_and_b32 v50, v52, v6
    v_and_b32 v51, v52, v7
    s_waitcnt vmcnt(5)
    s_nop 0
    v_mfma_f32_16x16x32_bf16 v[12:15], v[48:51], v[96:99], v[12:15]
    v_perm_b32 v60, v43, v43, s74
    v_and_b32 v56, v60, v4
    v_and_b32 v57, v60, v5
    v_and_b32 v58, v60, v6
    v_and_b32 v59, v60, v7
    s_nop 1
    v_mfma_f32_16x16x32_bf16 v[16:19], v[56:59], v[96:99], v[16:19]
    v_perm_b32 v52, v36, v36, s75
    v_and_b32 v48, v52, v4
    v_and_b32 v49, v52, v5
    v_and_b32 v50, v52, v6
    v_and_b32 v51, v52, v7
    s_nop 1
    v_mfma_f32_16x16x32_bf16 v[12:15], v[48:51], v[100:103], v[12:15]
    v_perm_b32 v60, v43, v43, s75
    v_and_b32 v56, v60, v4
    v_and_b32 v57, v60, v5
    v_and_b32 v58, v60, v6
    v_and_b32 v59, v60, v7
    s_nop 1
    v_mfma_f32_16x16x32_bf16 v[16:19], v[56:59], v[100:103], v[16:19]
    v_perm_b32 v52, v37, v37, s74
    v_and_b32 v48, v52, v4
    v_and_b32 v49, v52, v5
    v_and_b32 v50, v52, v6
    v_and_b32 v51, v52, v7
    s_waitcnt vmcnt(3)
    s_nop 0
    v_mfma_f32_16x16x32_bf16 v[12:15], v[48:51], v[104:107], v[12:15]
    v_perm_b32 v60, v44, v44, s74
    v_and_b32 v56, v60, v4
    v_and_b32 v57, v60, v5
    v_and_b32 v58, v60, v6
    v_and_b32 v59, v60, v7
    s_nop 1
    v_mfma_f32_16x16x32_bf16 v[16:19], v[56:59], v[104:107], v[16:19]
    v_perm_b32 v52, v37, v37, s75
    v_and_b32 v48, v52, v4
    v_and_b32 v49, v52, v5
    v_and_b32 v50, v52, v6
    v_and_b32 v51, v52, v7
    s_nop 1
    v_mfma_f32_16x16x32_bf16 v[12:15], v[48:51], v[108:111], v[12:15]
    v_perm_b32 v60, v44, v44, s75
    v_and_b32 v56, v60, v4
    v_and_b32 v57, v60, v5
    v_and_b32 v58, v60, v6
    v_and_b32 v59, v60, v7
    s_nop 1
    v_mfma_f32_16x16x32_bf16 v[16:19], v[56:59], v[108:111], v[16:19]
    v_perm_b32 v52, v38, v38, s74
    v_and_b32 v48, v52, v4
    v_and_b32 v49, v52, v5
    v_and_b32 v50, v52, v6
    v_and_b32 v51, v52, v7
    s_waitcnt vmcnt(1)
    s_nop 0
    v_mfma_f32_16x16x32_bf16 v[12:15], v[48:51], v[112:115], v[12:15]
    v_perm_b32 v60, v45, v45, s74
    v_and_b32 v56, v60, v4
    v_and_b32 v57, v60, v5
    v_and_b32 v58, v60, v6
    v_and_b32 v59, v60, v7
    s_nop 1
    v_mfma_f32_16x16x32_bf16 v[16:19], v[56:59], v[112:115], v[16:19]
    v_perm_b32 v52, v38, v38, s75
    v_and_b32 v48, v52, v4
    v_and_b32 v49, v52, v5
    v_and_b32 v50, v52, v6
    v_and_b32 v51, v52, v7
    s_nop 1
    v_mfma_f32_16x16x32_bf16 v[12:15], v[48:51], v[116:119], v[12:15]
    v_perm_b32 v60, v45, v45, s75
    v_and_b32 v56, v60, v4
    v_and_b32 v57, v60, v5
    v_and_b32 v58, v60, v6
    v_and_b32 v59, v60, v7
    s_nop 1
    v_mfma_f32_16x16x32_bf16 v[16:19], v[56:59], v[116:119], v[16:19]
    s_nop 7
    v_add_f32_dpp v12, v16, v12 row_ror:8 row_mask:0xf bank_mask:0xf
    v_add_f32_dpp v13, v17, v13 row_ror:8 row_mask:0xf bank_mask:0xf
    v_add_f32_dpp v14, v18, v14 row_ror:8 row_mask:0xf bank_mask:0xf
    v_add_f32_dpp v15, v19, v15 row_ror:8 row_mask:0xf bank_mask:0xf
    s_mov_b32 s34, 0
    s_mov_b32 s76, 50000
    s_waitcnt vmcnt(0)
L_q_pub:
    s_mov_b64 s[70:71], exec
    s_mov_b64 exec, -1
    s_cmp_eq_u32 s34, 7
    s_cselect_b32 s34, 0, s34
    s_add_u32 s34, s34, 1
    v_add_u32 v16, s34, v120
    v_add_u32 v17, s34, v121
    v_add_u32 v18, s34, v122
    v_add_u32 v19, s34, v123
    v_bfi_b32 v16, 7, v16, v12
    v_bfi_b32 v17, 7, v17, v13
    v_bfi_b32 v18, 7, v18, v14
    v_bfi_b32 v19, 7, v19, v15
    buffer_store_dwordx4 v[16:19], v2, s[44:47], s66 offen sc1
    s_mov_b64 exec, s[70:71]
    s_mov_b32 s68, 3
    s_sleep 40
L_q_poll:
    buffer_load_dwordx4 v[160:163], v27, s[44:47], s67 offen offset:0 sc1
    buffer_load_dwordx4 v[164:167], v27, s[44:47], s67 offen offset:1024 sc1
    buffer_load_dwordx4 v[168:171], v27, s[44:47], s67 offen offset:2048 sc1
    buffer_load_dwordx4 v[172:175], v27, s[44:47], s67 offen offset:3072 sc1
    buffer_load_dwordx4 v[176:179], v27, s[44:47], s69 offen offset:0 sc1
    buffer_load_dwordx4 v[180:183], v27, s[44:47], s69 offen offset:1024 sc1
    buffer_load_dwordx4 v[184:187], v27, s[44:47], s69 offen offset:2048 sc1
    buffer_load_dwordx4 v[188:191], v27, s[44:47], s69 offen offset:3072 sc1
    s_waitcnt vmcnt(0)
    v_bitop3_b32 v64, v160, v128, 7 bitop3:0x28
    v_bitop3_b32 v65, v161, v129, 7 bitop3:0x28
    v_bitop3_b32 v66, v162, v130, 7 bitop3:0x28
    v_bitop3_b32 v67, v163, v131, 7 bitop3:0x28
    v_bitop3_b32 v68, v164, v132, 7 bitop3:0x28
    v_bitop3_b32 v69, v165, v133, 7 bitop3:0x28
    v_bitop3_b32 v70, v166, v134, 7 bitop3:0x28
    v_bitop3_b32 v71, v167, v135, 7 bitop3:0x28
    v_bitop3_b32 v72, v168, v136, 7 bitop3:0x28
    v_bitop3_b32 v73, v169, v137, 7 bitop3:0x28
    v_bitop3_b32 v74, v170, v138, 7 bitop3:0x28
    v_bitop3_b32 v75, v171, v139, 7 bitop3:0x28
    v_bitop3_b32 v76, v172, v140, 7 bitop3:0x28
    v_bitop3_b32 v77, v173, v141, 7 bitop3:0x28
    v_bitop3_b32 v78, v174, v142, 7 bitop3:0x28
    v_bitop3_b32 v79, v175, v143, 7 bitop3:0x28
    v_bitop3_b32 v80, v176, v144, 7 bitop3:0x28
    v_bitop3_b32 v81, v177, v145, 7 bitop3:0x28
    v_bitop3_b32 v82, v178, v146, 7 bitop3:0x28
    v_bitop3_b32 v83, v179, v147, 7 bitop3:0x28
    v_bitop3_b32 v84, v180, v148, 7 bitop3:0x28
    v_bitop3_b32 v85, v181, v149, 7 bitop3:0x28
    v_bitop3_b32 v86, v182, v150, 7 bitop3:0x28
    v_bitop3_b32 v87, v183, v151, 7 bitop3:0x28
    v_bitop3_b32 v88, v184, v152, 7 bitop3:0x28
    v_bitop3_b32 v89, v185, v153, 7 bitop3:0x28
    v_bitop3_b32 v90, v186, v154, 7 bitop3:0x28
    v_bitop3_b32 v91, v187, v155, 7 bitop3:0x28
    v_bitop3_b32 v92, v188, v156, 7 bitop3:0x28
    v_bitop3_b32 v93, v189, v157, 7 bitop3:0x28
    v_bitop3_b32 v94, v190, v158, 7 bitop3:0x28
    v_bitop3_b32 v95, v191, v159, 7 bitop3:0x28
    v_min_u32 v10, v64, v65
    v_min3_u32 v10, v10, v66, v67
    v_min3_u32 v10, v10, v68, v69
    v_min3_u32 v10, v10, v70, v71
    v_min3_u32 v10, v10, v72, v73
    v_min3_u32 v10, v10, v74, v75
    v_min3_u32 v10, v10, v76, v77
    v_min3_u32 v10, v10, v78, v79
    v_min3_u32 v10, v10, v80, v81
    v_min3_u32 v10, v10, v82, v83
    v_min3_u32 v10, v10, v84, v85
    v_min3_u32 v10, v10, v86, v87
    v_min3_u32 v10, v10, v88, v89
    v_min3_u32 v10, v10, v90, v91
    v_min3_u32 v10, v10, v92, v93
    v_min3_u32 v10, v10, v94, v95
    v_cmp_eq_u32 vcc, 0, v10
    s_cbranch_vccz L_q_got
    s_mov_b64 exec, vcc
    s_sub_u32 s76, s76, 1
    s_cmp_eq_u32 s76, 0
    s_cbranch_scc1 L_q_got
    s_sub_u32 s68, s68, 1
    s_cmp_lg_u32 s68, 0
    s_cbranch_scc1 L_q_poll
    s_branch L_q_pub
L_q_got:
    s_mov_b64 exec, -1
    v_and_b32 v160, -8, v160
    v_and_b32 v161, -8, v161
    v_and_b32 v162, -8, v162
    v_and_b32 v163, -8, v163
    v_and_b32 v164, -8, v164
    v_and_b32 v165, -8, v165
    v_and_b32 v166, -8, v166
    v_and_b32 v167, -8, v167
    v_and_b32 v168, -8, v168
    v_and_b32 v169, -8, v169
    v_and_b32 v170, -8, v170
    v_and_b32 v171, -8, v171
    v_and_b32 v172, -8, v172
    v_and_b32 v173, -8, v173
    v_and_b32 v174, -8, v174
    v_and_b32 v175, -8, v175
    v_and_b32 v176, -8, v176
    v_and_b32 v177, -8, v177
    v_and_b32 v178, -8, v178
    v_and_b32 v179, -8, v179
    v_and_b32 v180, -8, v180
    v_and_b32 v181, -8, v181
    v_and_b32 v182, -8, v182
    v_and_b32 v183, -8, v183
    v_and_b32 v184, -8, v184
    v_and_b32 v185, -8, v185
    v_and_b32 v186, -8, v186
    v_and_b32 v187, -8, v187
    v_and_b32 v188, -8, v188
    v_and_b32 v189, -8, v189
    v_and_b32 v190, -8, v190
    v_and_b32 v191, -8, v191
    v_add_f32 v160, v160, v168
    v_add_f32 v161, v161, v169
    v_add_f32 v162, v162, v170
    v_add_f32 v163, v163, v171
    v_add_f32 v164, v164, v172
    v_add_f32 v165, v165, v173
    v_add_f32 v166, v166, v174
    v_add_f32 v167, v167, v175
    v_add_f32 v160, v160, v176
    v_add_f32 v161, v161, v177
    v_add_f32 v162, v162, v178
    v_add_f32 v163, v163, v179
    v_add_f32 v164, v164, v180
    v_add_f32 v165, v165, v181
    v_add_f32 v166, v166, v182
    v_add_f32 v167, v167, v183
    v_add_f32 v160, v160, v184
    v_add_f32 v161, v161, v185
    v_add_f32 v162, v162, v186
    v_add_f32 v163, v163, v187
    v_add_f32 v164, v164, v188
    v_add_f32 v165, v165, v189
    v_add_f32 v166, v166, v190
    v_add_f32 v167, v167, v191
    v_cvt_pk_bf16_f32 v48, v160, v161
    v_cvt_pk_bf16_f32 v49, v162, v163
    v_cvt_pk_bf16_f32 v50, v164, v165
    v_cvt_pk_bf16_f32 v51, v166, v167
    v_lshlrev_b32 v10, 3, v0
    ds_write_b64 v10, v[48:49] offset:256
    ds_write_b64 v10, v[50:51] offset:768
    v_mov_b32 v10, 1
    s_waitcnt lgkmcnt(0)
    ds_write_b32 v8, v10 offset:4
    s_mov_b32 s76, 50000
    s_sleep 24
    s_cmp_eq_u32 s34, 7
    s_cselect_b32 s34, 0, s34
    s_add_u32 s34, s34, 1
    v_add_u32 v16, s34, v120
    v_add_u32 v17, s34, v121
    v_add_u32 v18, s34, v122
    v_add_u32 v19, s34, v123
    v_bfi_b32 v16, 7, v16, v12
    v_bfi_b32 v17, 7, v17, v13
    v_bfi_b32 v18, 7, v18, v14
    v_bfi_b32 v19, 7, v19, v15
    buffer_store_dwordx4 v[16:19], v2, s[44:47], s66 offen sc1
    s_sleep 24
    s_cmp_eq_u32 s34, 7
    s_cselect_b32 s34, 0, s34
    s_add_u32 s34, s34, 1
    v_add_u32 v16, s34, v120
    v_add_u32 v17, s34, v121
    v_add_u32 v18, s34, v122
    v_add_u32 v19, s34, v123
    v_bfi_b32 v16, 7, v16, v12
    v_bfi_b32 v17, 7, v17, v13
    v_bfi_b32 v18, 7, v18, v14
    v_bfi_b32 v19, 7, v19, v15
    buffer_store_dwordx4 v[16:19], v2, s[44:47], s66 offen sc1
    s_add_u32 s58, s32, 32
    s_mul_i32 s58, s58, 4352
    s_add_u32 s58, s58, 5242880
    s_mov_b32 s52, s58
L_q_ack:
    s_sleep 127
    buffer_load_dword v10, v8, s[44:47], s52 offen sc1
    s_waitcnt vmcnt(0)
    v_readfirstlane_b32 s58, v10
    s_nop 0
    s_cmp_ge_u32 s58, 32
    s_cbranch_scc1 L_q_allok
    s_cmp_eq_u32 s34, 7
    s_cselect_b32 s34, 0, s34
    s_add_u32 s34, s34, 1
    v_add_u32 v16, s34, v120
    v_add_u32 v17, s34, v121
    v_add_u32 v18, s34, v122
    v_add_u32 v19, s34, v123
    v_bfi_b32 v16, 7, v16, v12
    v_bfi_b32 v17, 7, v17, v13
    v_bfi_b32 v18, 7, v18, v14
    v_bfi_b32 v19, 7, v19, v15
    buffer_store_dwordx4 v[16:19], v2, s[44:47], s66 offen sc1
    s_sub_u32 s76, s76, 1
    s_cmp_gt_i32 s76, 0
    s_cbranch_scc1 L_q_ack
L_q_allok:
    v_mov_b32 v10, 1
    ds_write_b32 v8, v10 offset:0
    s_mov_b32 s76, 400000
L_m_wait:
    ds_read_b32 v10, v8 offset:20
    s_waitcnt lgkmcnt(0)
    v_readfirstlane_b32 s58, v10
    s_nop 0
    s_cmp_ge_u32 s58, 4
    s_cbranch_scc1 L_m_go
    s_sleep 16
    s_sub_u32 s76, s76, 1
    s_cmp_gt_i32 s76, 0
    s_cbranch_scc1 L_m_wait
L_m_go:
    v_mov_b32 v16, 0xff61b1e6
    v_mov_b32 v17, 0
    v_mov_b32 v18, 0xff61b1e6
    v_mov_b32 v19, 0
    v_mov_b32 v11, 0xff80ff80
    v_add_u32 v3, 19456, v27
    v_lshrrev_b32 v1, 2, v0
L_m_st:
    ds_read_b128 v[12:15], v3
    v_cmp_gt_u32 vcc, s78, v1
    s_waitcnt lgkmcnt(0)
    s_call_b64 s[60:61], L_fold
    v_add_u32 v3, 0x400, v3
    v_add_u32 v1, 16, v1
    v_cmp_gt_u32 vcc, s78, v1
    s_cbranch_vccnz L_m_st
    v_add_u32 v3, 27648, v27
    v_and_b32 v1, 60, v0
L_m_pl:
    ds_read_b32 v10, v1 offset:15360
    ds_read_b128 v[12:15], v3
    s_waitcnt lgkmcnt(0)
    v_add_u32 v10, -1, v10
    v_cmp_gt_u32 vcc, 2047, v10
    s_call_b64 s[60:61], L_fold
    v_add_u32 v3, 0x400, v3
    v_add_u32 v1, 64, v1
    s_cmp_eq_u64 vcc, -1
    s_cbranch_scc1 L_m_pl
    v_mov_b32 v32, v16
    v_mov_b32 v33, v18
    s_nop 0
    v_max_f32_dpp v32, v32, v32 row_ror:8 row_mask:0xf bank_mask:0xf
    v_max_f32_dpp v33, v33, v33 row_ror:8 row_mask:0xf bank_mask:0xf
    s_nop 0
    v_max_f32_dpp v32, v32, v32 row_ror:4 row_mask:0xf bank_mask:0xf
    v_max_f32_dpp v33, v33, v33 row_ror:4 row_mask:0xf bank_mask:0xf
    s_nop 0
    v_max_f32_dpp v32, v32, v32 row_ror:2 row_mask:0xf bank_mask:0xf
    v_max_f32_dpp v33, v33, v33 row_ror:2 row_mask:0xf bank_mask:0xf
    s_nop 0
    v_max_f32_dpp v32, v32, v32 row_ror:1 row_mask:0xf bank_mask:0xf
    v_max_f32_dpp v33, v33, v33 row_ror:1 row_mask:0xf bank_mask:0xf
    v_mov_b32 v34, v32
    v_mov_b32 v35, v33
    s_nop 0
    v_permlane16_swap_b32 v34, v32
    v_permlane16_swap_b32 v35, v33
    v_max_f32 v32, v34, v32
    v_max_f32 v33, v35, v33
    v_mov_b32 v34, v32
    v_mov_b32 v35, v33
    s_nop 0
    v_permlane32_swap_b32 v34, v32
    v_permlane32_swap_b32 v35, v33
    v_max_f32 v32, v34, v32
    v_max_f32 v33, v35, v33
    v_sub_f32 v34, v16, v32
    v_sub_f32 v35, v18, v33
    v_mul_f32 v34, s62, v34
    v_mul_f32 v35, s62, v35
    v_exp_f32 v34, v34
    v_exp_f32 v35, v35
    v_mov_b32 v16, v32
    v_mov_b32 v18, v33
    v_mul_f32 v17, v17, v34
    v_mul_f32 v19, v19, v35
    s_nop 0
    v_add_f32_dpp v17, v17, v17 row_ror:8 row_mask:0xf bank_mask:0xf
    v_add_f32_dpp v19, v19, v19 row_ror:8 row_mask:0xf bank_mask:0xf
    s_nop 0
    v_add_f32_dpp v17, v17, v17 row_ror:4 row_mask:0xf bank_mask:0xf
    v_add_f32_dpp v19, v19, v19 row_ror:4 row_mask:0xf bank_mask:0xf
    s_nop 0
    v_add_f32_dpp v17, v17, v17 row_ror:2 row_mask:0xf bank_mask:0xf
    v_add_f32_dpp v19, v19, v19 row_ror:2 row_mask:0xf bank_mask:0xf
    s_nop 0
    v_add_f32_dpp v17, v17, v17 row_ror:1 row_mask:0xf bank_mask:0xf
    v_add_f32_dpp v19, v19, v19 row_ror:1 row_mask:0xf bank_mask:0xf
    v_mov_b32 v34, v17
    v_mov_b32 v35, v19
    s_nop 0
    v_permlane16_swap_b32 v34, v17
    v_permlane16_swap_b32 v35, v19
    v_add_f32 v17, v34, v17
    v_add_f32 v19, v35, v19
    v_mov_b32 v34, v17
    v_mov_b32 v35, v19
    s_nop 0
    v_permlane32_swap_b32 v34, v17
    v_permlane32_swap_b32 v35, v19
    v_add_f32 v17, v34, v17
    v_add_f32 v19, v35, v19
    v_min_u32 v16, -2, v16
    v_min_u32 v17, -2, v17
    v_min_u32 v18, -2, v18
    v_min_u32 v19, -2, v19
    s_mov_b32 s76, 400000
L_lw_56:
    ds_read_b32 v10, v8 offset:28
    s_waitcnt lgkmcnt(0)
    v_readfirstlane_b32 s58, v10
    s_nop 0
    s_cmp_lg_u32 s58, 0
    s_cbranch_scc1 L_lwd_57
    s_sleep 4
    s_sub_u32 s76, s76, 1
    s_cmp_gt_i32 s76, 0
    s_cbranch_scc1 L_lw_56
L_lwd_57:
    v_cmp_eq_u32 vcc, 0, v0
    s_nop 1
    v_cndmask_b32 v1, v9, v8, vcc
    s_lshl_b32 s58, s2, 4
    s_add_u32 s58, s58, 2097152
    buffer_store_dwordx4 v[16:19], v1, s[44:47], s58 offen sc1
    v_and_b32 v1, 0xf0, v27
    s_lshl_b32 s58, s29, 8
    s_add_u32 s58, s58, 2097152
    s_mov_b32 s76, 50000
L_m_poll:
    s_sleep 24
    buffer_load_dwordx4 v[16:19], v1, s[44:47], s58 offen sc1
    s_waitcnt vmcnt(0)
    v_max3_u32 v10, v16, v17, v18
    v_max_u32 v10, v10, v19
    v_cmp_eq_u32 vcc, -1, v10
    s_cbranch_vccz L_m_all
    s_sub_u32 s76, s76, 1
    s_cmp_gt_i32 s76, 0
    s_cbranch_scc1 L_m_poll
L_m_all:
    v_mov_b32 v32, v16
    v_mov_b32 v33, v18
    s_nop 0
    v_max_f32_dpp v32, v32, v32 row_ror:8 row_mask:0xf bank_mask:0xf
    v_max_f32_dpp v33, v33, v33 row_ror:8 row_mask:0xf bank_mask:0xf
    s_nop 0
    v_max_f32_dpp v32, v32, v32 row_ror:4 row_mask:0xf bank_mask:0xf
    v_max_f32_dpp v33, v33, v33 row_ror:4 row_mask:0xf bank_mask:0xf
    s_nop 0
    v_max_f32_dpp v32, v32, v32 row_ror:2 row_mask:0xf bank_mask:0xf
    v_max_f32_dpp v33, v33, v33 row_ror:2 row_mask:0xf bank_mask:0xf
    s_nop 0
    v_max_f32_dpp v32, v32, v32 row_ror:1 row_mask:0xf bank_mask:0xf
    v_max_f32_dpp v33, v33, v33 row_ror:1 row_mask:0xf bank_mask:0xf
    v_sub_f32 v34, v16, v32
    v_sub_f32 v35, v18, v33
    v_mul_f32 v34, s62, v34
    v_mul_f32 v35, s62, v35
    v_exp_f32 v34, v34
    v_exp_f32 v35, v35
    v_mov_b32 v16, v32
    v_mov_b32 v18, v33
    v_mul_f32 v17, v17, v34
    v_mul_f32 v19, v19, v35
    s_nop 0
    v_add_f32_dpp v17, v17, v17 row_ror:8 row_mask:0xf bank_mask:0xf
    v_add_f32_dpp v19, v19, v19 row_ror:8 row_mask:0xf bank_mask:0xf
    s_nop 0
    v_add_f32_dpp v17, v17, v17 row_ror:4 row_mask:0xf bank_mask:0xf
    v_add_f32_dpp v19, v19, v19 row_ror:4 row_mask:0xf bank_mask:0xf
    s_nop 0
    v_add_f32_dpp v17, v17, v17 row_ror:2 row_mask:0xf bank_mask:0xf
    v_add_f32_dpp v19, v19, v19 row_ror:2 row_mask:0xf bank_mask:0xf
    s_nop 0
    v_add_f32_dpp v17, v17, v17 row_ror:1 row_mask:0xf bank_mask:0xf
    v_add_f32_dpp v19, v19, v19 row_ror:1 row_mask:0xf bank_mask:0xf
    v_log_f32 v17, v17
    v_log_f32 v19, v19
    v_sub_f32 v17, 0, v17
    v_sub_f32 v19, 0, v19
    ds_write_b128 v8, v[16:19] offset:32
    v_mov_b32 v10, 1
    s_waitcnt lgkmcnt(0)
    ds_write_b32 v8, v10 offset:24
    s_branch L_tailw
L_fold:
    s_nop 1
    v_cndmask_b32 v12, v11, v12, vcc
    v_cndmask_b32 v13, v11, v13, vcc
    v_cndmask_b32 v14, v11, v14, vcc
    v_cndmask_b32 v15, v11, v15, vcc
    v_lshlrev_b32 v32, 16, v12
    v_and_b32 v33, 0xffff0000, v12
    v_lshlrev_b32 v34, 16, v13
    v_and_b32 v35, 0xffff0000, v13
    v_max3_f32 v36, v32, v33, v16
    v_max3_f32 v36, v34, v35, v36
    v_sub_f32 v37, v16, v36
    v_sub_f32 v32, v32, v36
    v_sub_f32 v33, v33, v36
    v_sub_f32 v34, v34, v36
    v_sub_f32 v35, v35, v36
    v_mul_f32 v37, s62, v37
    v_mul_f32 v32, s62, v32
    v_mul_f32 v33, s62, v33
    v_mul_f32 v34, s62, v34
    v_mul_f32 v35, s62, v35
    v_exp_f32 v37, v37
    v_exp_f32 v32, v32
    v_exp_f32 v33, v33
    v_exp_f32 v34, v34
    v_exp_f32 v35, v35
    v_mov_b32 v16, v36
    v_add_f32 v32, v32, v33
    v_add_f32 v34, v34, v35
    v_add_f32 v32, v32, v34
    v_fma_f32 v17, v17, v37, v32
    v_lshlrev_b32 v32, 16, v14
    v_and_b32 v33, 0xffff0000, v14
    v_lshlrev_b32 v34, 16, v15
    v_and_b32 v35, 0xffff0000, v15
    v_max3_f32 v36, v32, v33, v18
    v_max3_f32 v36, v34, v35, v36
    v_sub_f32 v37, v18, v36
    v_sub_f32 v32, v32, v36
    v_sub_f32 v33, v33, v36
    v_sub_f32 v34, v34, v36
    v_sub_f32 v35, v35, v36
    v_mul_f32 v37, s62, v37
    v_mul_f32 v32, s62, v32
    v_mul_f32 v33, s62, v33
    v_mul_f32 v34, s62, v34
    v_mul_f32 v35, s62, v35
    v_exp_f32 v37, v37
    v_exp_f32 v32, v32
    v_exp_f32 v33, v33
    v_exp_f32 v34, v34
    v_exp_f32 v35, v35
    v_mov_b32 v18, v36
    v_add_f32 v32, v32, v33
    v_add_f32 v34, v34, v35
    v_add_f32 v32, v32, v34
    v_fma_f32 v19, v19, v37, v32
    s_setpc_b64 s[60:61]
L_helper:
    v_mov_b32 v9, 0x7fffff00
    v_mov_b32 v8, 0
    s_cmp_lg_u32 s28, 7
    s_cbranch_scc1 L_h_noinit
    v_mov_b32 v10, 28
    ds_write_b32 v8, v8 offset:16
    ds_write_b32 v8, v8 offset:20
    ds_write_b32 v8, v8 offset:24
    ds_write_b32 v8, v8 offset:28
    ds_write_b32 v8, v8 offset:0
    ds_write_b32 v8, v8 offset:4
    ds_write_b32 v8, v10 offset:8
    ds_write_b32 v8, v8 offset:12
    v_mov_b32 v10, -1
    v_and_b32 v1, 60, v0
    ds_write_b32 v1, v10 offset:64
    v_mov_b32 v12, 0
    v_mov_b32 v13, 0
    v_mov_b32 v14, 0
    v_mov_b32 v15, 0
    ds_write_b128 v27, v[12:15] offset:15360
    ds_write_b128 v27, v[12:15] offset:16384
    ds_write_b128 v27, v[12:15] offset:17408
    ds_write_b128 v27, v[12:15] offset:18432
    v_mov_b32 v12, -1
    v_mov_b32 v13, -1
    v_mov_b32 v14, -1
    v_mov_b32 v15, -1
    ds_write_b128 v27, v[12:15] offset:19456
    ds_write_b128 v27, v[12:15] offset:20480
    ds_write_b128 v27, v[12:15] offset:21504
    ds_write_b128 v27, v[12:15] offset:22528
    ds_write_b128 v27, v[12:15] offset:23552
    ds_write_b128 v27, v[12:15] offset:24576
    ds_write_b128 v27, v[12:15] offset:25600
    ds_write_b128 v27, v[12:15] offset:26624
L_h_noinit:
    s_sub_u32 s58, s30, s29
    s_and_b32 s58, s58, 15
    s_lshl_b32 s35, s58, 1
    s_add_u32 s35, s35, s29
    s_and_b32 s58, s58, 7
    s_cmp_eq_u32 s58, 0
    s_cselect_b32 s35, s35, 255
    s_waitcnt lgkmcnt(0)
    s_mov_b32 s44, s26
    s_mov_b32 s45, s27
    s_mov_b32 s46, 16777216
    s_mov_b32 s47, 0x00020000
    s_cmp_lg_u32 s28, 5
    s_cbranch_scc1 L_h_ffn
    v_mov_b32 v12, -1
    v_mov_b32 v13, -1
    v_mov_b32 v14, -1
    v_mov_b32 v15, -1
    v_lshrrev_b32 v1, 3, v0
    v_lshlrev_b32 v1, 11, v1
    v_and_b32 v10, 7, v0
    v_lshl_add_u32 v1, v10, 4, v1
    s_lshl_b32 s58, s29, 15
    s_lshl_b32 s59, s30, 7
    s_add_u32 s58, s58, s59
    s_add_u32 s58, s58, 1048576
    buffer_store_dwordx4 v[12:15], v1, s[44:47], s58 offen sc1
    s_add_u32 s58, s58, 0x4000
    buffer_store_dwordx4 v[12:15], v1, s[44:47], s58 offen sc1
    v_cmp_eq_u32 vcc, 0, v0
    s_nop 1
    v_cndmask_b32 v1, v9, v8, vcc
    s_lshl_b32 s58, s2, 4
    s_add_u32 s58, s58, 2097152
    buffer_store_dwordx4 v[12:15], v1, s[44:47], s58 offen sc1
    s_lshl_b32 s58, s2, 11
    s_add_u32 s58, s58, 3145728
    buffer_store_dwordx4 v[12:15], v27, s[44:47], s58 offen sc1
    buffer_store_dwordx4 v[12:15], v27, s[44:47], s58 offen offset:1024 sc1
    s_cmp_ge_u32 s35, 28
    s_cbranch_scc1 L_h_noyb
    s_lshl_b32 s58, s35, 12
    s_add_u32 s58, s58, 4194304
    buffer_store_dwordx4 v[12:15], v27, s[44:47], s58 offen offset:0 sc1
    buffer_store_dwordx4 v[12:15], v27, s[44:47], s58 offen offset:1024 sc1
    buffer_store_dwordx4 v[12:15], v27, s[44:47], s58 offen offset:2048 sc1
    buffer_store_dwordx4 v[12:15], v27, s[44:47], s58 offen offset:3072 sc1
L_h_noyb:
    s_barrier
    s_add_u32 s58, s32, 32
    s_mul_i32 s58, s58, 4352
    s_add_u32 s58, s58, 5242880
    s_add_u32 s52, s26, s58
    s_addc_u32 s53, s27, 0
    s_waitcnt vmcnt(0)
    s_mov_b32 s76, 400000
L_lw_58:
    ds_read_b32 v10, v8 offset:4
    s_waitcnt lgkmcnt(0)
    v_readfirstlane_b32 s58, v10
    s_nop 0
    s_cmp_lg_u32 s58, 0
    s_cbranch_scc1 L_lwd_59
    s_sleep 4
    s_sub_u32 s76, s76, 1
    s_cmp_gt_i32 s76, 0
    s_cbranch_scc1 L_lw_58
L_lwd_59:
    s_mov_b32 s58, 1
    s_atomic_add s58, s[52:53], 0 glc
    s_waitcnt lgkmcnt(0)
    s_cmp_lg_u32 s58, 31
    s_cbranch_scc1 L_agent
    s_mov_b32 s58, 1
    s_atomic_add s58, s[24:25], 0
L_agent:
    s_lshr_b32 s58, s2, 3
    s_mul_i32 s58, s58, 4352
    s_add_u32 s58, s58, 5242880
    s_add_u32 s52, s26, s58
    s_addc_u32 s53, s27, 0
    s_lshl_b32 s67, s29, 17
    s_add_u32 s67, s67, 6291456
    s_sub_u32 s64, s78, 2
    v_lshlrev_b32 v1, 2, v0
    v_add_u32 v3, 60416, v27
    s_mov_b32 s76, 400000
L_ag1_loop:
    ds_read_b32 v10, v8 offset:8
    s_waitcnt lgkmcnt(0)
    v_readfirstlane_b32 s58, v10
    s_nop 0
    s_cmp_ge_u32 s58, s64
    s_cbranch_scc1 L_ag1_claim
    s_add_u32 s58, s58, 24
    s_cmp_ge_u32 s58, s64
    s_cbranch_scc1 L_ag1_short
    s_sleep 64
L_ag1_short:
    s_sleep 2
    s_sub_u32 s76, s76, 1
    s_cmp_gt_i32 s76, 0
    s_cbranch_scc1 L_ag1_loop
L_ag1_claim:
    s_mov_b32 s57, 1
    s_atomic_add s57, s[52:53], 0 glc
    s_waitcnt lgkmcnt(0)
    s_cmp_ge_u32 s57, 20
    s_cbranch_scc1 L_ag1_end
    s_mul_i32 s54, s57, 16
    s_add_u32 s54, s54, 0
    s_mov_b32 s55, 16
    s_cmp_lt_u32 s57, 12
    s_cbranch_scc1 L_ag1_put
    s_mul_i32 s54, s57, 8
    s_add_u32 s54, s54, 96
    s_mov_b32 s55, 8
L_ag1_put:
    s_lshr_b32 s58, s54, 4
    s_and_b32 s54, s54, 15
    s_and_b32 s59, s58, 7
    s_and_b32 s65, s30, 8
    s_add_u32 s59, s59, s65
    s_lshl_b32 s59, s59, 7
    s_add_u32 s54, s54, s59
    s_lshr_b32 s58, s58, 3
    s_lshl_b32 s58, s58, 4
    s_add_u32 s54, s54, s58
    s_add_u32 s54, s54, 96
L_ag1_wr:
    v_add_u32 v10, s54, v0
    s_bfm_b64 exec, s55, 0
    ds_write_b32 v1, v10 offset:15360
    s_mov_b64 exec, -1
    s_lshl_b32 s58, s55, 2
    v_add_u32 v1, s58, v1
    s_add_u32 s64, s64, s55
    s_branch L_ag1_loop
L_ag1_end:
    v_mov_b32 v10, 2048
    ds_write_b32 v1, v10 offset:15360
    s_mov_b32 s76, 400000
L_fl_wait:
    ds_read_b32 v10, v8 offset:20
    s_waitcnt lgkmcnt(0)
    v_readfirstlane_b32 s58, v10
    s_nop 0
    s_cmp_ge_u32 s58, 4
    s_cbranch_scc1 L_fl_go
    s_sleep 8
    s_sub_u32 s76, s76, 1
    s_cmp_gt_i32 s76, 0
    s_cbranch_scc1 L_fl_wait
L_fl_go:
    v_and_b32 v1, 60, v0
    v_add_u32 v3, 27648, v27
    v_and_b32 v11, 3, v0
    v_lshlrev_b32 v11, 4, v11
L_fl_loop:
    ds_read_b32 v10, v1 offset:15360
    ds_read_b128 v[12:15], v3
    s_waitcnt lgkmcnt(0)
    v_lshl_add_u32 v2, v10, 6, v11
    v_cmp_gt_u32 vcc, 2048, v10
    s_nop 1
    v_cndmask_b32 v2, v9, v2, vcc
    buffer_store_dwordx4 v[12:15], v2, s[44:47], s67 offen sc1
    v_add_u32 v1, 64, v1
    v_add_u32 v3, 0x400, v3
    s_cmp_eq_u64 vcc, -1
    s_cbranch_scc1 L_fl_loop
    s_waitcnt vmcnt(0)
    v_mov_b32 v10, 1
    ds_write_b32 v8, v10 offset:28
    s_mov_b32 s76, 400000
L_lw_60:
    ds_read_b32 v10, v8 offset:24
    s_waitcnt lgkmcnt(0)
    v_readfirstlane_b32 s58, v10
    s_nop 0
    s_cmp_lg_u32 s58, 0
    s_cbranch_scc1 L_lwd_61
    s_sleep 16
    s_sub_u32 s76, s76, 1
    s_cmp_gt_i32 s76, 0
    s_cbranch_scc1 L_lw_60
L_lwd_61:
    s_sub_u32 s64, s78, 1
    v_lshlrev_b32 v1, 2, v0
    v_add_u32 v3, 60416, v27
    s_mov_b32 s76, 400000
L_ag2_loop:
    ds_read_b32 v10, v8 offset:16
    s_waitcnt lgkmcnt(0)
    v_readfirstlane_b32 s58, v10
    s_nop 0
    s_cmp_ge_u32 s58, s64
    s_cbranch_scc1 L_ag2_claim
    s_add_u32 s58, s58, 24
    s_cmp_ge_u32 s58, s64
    s_cbranch_scc1 L_ag2_short
    s_sleep 64
L_ag2_short:
    s_sleep 2
    s_sub_u32 s76, s76, 1
    s_cmp_gt_i32 s76, 0
    s_cbranch_scc1 L_ag2_loop
L_ag2_claim:
    s_mov_b32 s57, 1
    s_atomic_add s57, s[52:53], 4 glc
    s_waitcnt lgkmcnt(0)
    s_cmp_ge_u32 s57, 33
    s_cbranch_scc1 L_ag2_end
    s_mul_i32 s54, s57, 16
    s_add_u32 s54, s54, 0
    s_mov_b32 s55, 16
    s_cmp_lt_u32 s57, 9
    s_cbranch_scc1 L_ag2_put
    s_mul_i32 s54, s57, 8
    s_add_u32 s54, s54, 72
    s_mov_b32 s55, 8
    s_cmp_lt_u32 s57, 17
    s_cbranch_scc1 L_ag2_put
    s_mul_i32 s54, s57, 4
    s_add_u32 s54, s54, 140
    s_mov_b32 s55, 4
    s_cmp_lt_u32 s57, 25
    s_cbranch_scc1 L_ag2_put
    s_mul_i32 s54, s57, 2
    s_add_u32 s54, s54, 190
    s_mov_b32 s55, 2
L_ag2_put:
    s_lshr_b32 s58, s54, 4
    s_and_b32 s54, s54, 15
    s_and_b32 s59, s58, 7
    s_and_b32 s65, s30, 8
    s_add_u32 s59, s59, s65
    s_lshl_b32 s59, s59, 7
    s_add_u32 s54, s54, s59
    s_lshr_b32 s58, s58, 3
    s_lshl_b32 s58, s58, 4
    s_add_u32 s54, s54, s58
    s_add_u32 s54, s54, 96
L_ag2_wr:
    s_lshl_b32 s58, s54, 6
    s_add_u32 s58, s58, s67
    s_lshl_b32 s59, s55, 2
    v_cmp_gt_u32 vcc, s59, v0
    s_nop 1
    v_cndmask_b32 v2, v9, v27, vcc
    buffer_load_dwordx4 v[12:15], v2, s[44:47], s58 offen sc1
    s_mov_b64 exec, vcc
    s_waitcnt vmcnt(0)
    ds_write_b128 v3, v[12:15]
    s_mov_b64 exec, -1
    s_lshl_b32 s58, s55, 6
    v_add_u32 v3, s58, v3
    v_add_u32 v10, s54, v0
    s_bfm_b64 exec, s55, 0
    ds_write_b32 v1, v10 offset:17408
    s_mov_b64 exec, -1
    s_lshl_b32 s58, s55, 2
    v_add_u32 v1, s58, v1
    s_add_u32 s64, s64, s55
    s_branch L_ag2_loop
L_ag2_end:
    v_mov_b32 v10, 2048
    ds_write_b32 v1, v10 offset:17408
    v_mov_b32 v10, 16
    s_mov_b64 exec, 1
    ds_add_u32 v8, v10 offset:12
    s_mov_b64 exec, -1
    s_branch L_tailw
L_h_ffn:
    s_barrier
    s_mov_b32 s76, 400000
L_lw_62:
    ds_read_b32 v10, v8 offset:4
    s_waitcnt lgkmcnt(0)
    v_readfirstlane_b32 s58, v10
    s_nop 0
    s_cmp_lg_u32 s58, 0
    s_cbranch_scc1 L_lwd_63
    s_sleep 8
    s_sub_u32 s76, s76, 1
    s_cmp_gt_i32 s76, 0
    s_cbranch_scc1 L_lw_62
L_lwd_63:
    s_cmp_eq_u32 s28, 7
    s_cbranch_scc1 L_tail
    s_cmp_ge_u32 s35, 28
    s_cbranch_scc1 L_tailw
    s_mov_b32 s74, 0x01000100
    s_mov_b32 s75, 0x03020302
    s_mov_b32 s40, s4
    s_mov_b32 s41, s5
    s_mov_b32 s42, 1792
    s_mov_b32 s43, 0x00020000
    v_lshrrev_b32 v1, 1, v0
    v_mul_u32_u24 v1, 28, v1
    v_and_b32 v10, 1, v0
    v_mul_u32_u24 v10, 896, v10
    v_add_u32 v1, v1, v10
    buffer_load_dwordx4 v[16:19], v1, s[40:43], 0 offen
    buffer_load_dwordx3 v[20:22], v1, s[40:43], 0 offen offset:16
    v_and_b32 v1, 1, v0
    v_lshlrev_b32 v1, 4, v1
    v_mov_b32 v52, 0xffff
    v_lshlrev_b32 v52, v1, v52
    v_bfe_u32 v1, v0, 1, 2
    v_cmp_eq_u32 vcc, 0, v1
    s_nop 1
    v_cndmask_b32 v4, 0, v52, vcc
    v_cmp_eq_u32 vcc, 1, v1
    s_nop 1
    v_cndmask_b32 v5, 0, v52, vcc
    v_cmp_eq_u32 vcc, 2, v1
    s_nop 1
    v_cndmask_b32 v6, 0, v52, vcc
    v_cmp_eq_u32 vcc, 3, v1
    s_nop 1
    v_cndmask_b32 v7, 0, v52, vcc
    s_mov_b32 s59, 2048
    s_waitcnt vmcnt(0)
    v_lshlrev_b32 v192, 16, v16
    v_and_b32 v193, 0xffff0000, v16
    v_lshlrev_b32 v194, 16, v17
    v_and_b32 v195, 0xffff0000, v17
    v_lshlrev_b32 v196, 16, v18
    v_and_b32 v197, 0xffff0000, v18
    v_lshlrev_b32 v198, 16, v19
    v_and_b32 v199, 0xffff0000, v19
    v_lshlrev_b32 v200, 16, v20
    v_and_b32 v201, 0xffff0000, v20
    v_lshlrev_b32 v202, 16, v21
    v_and_b32 v203, 0xffff0000, v21
    v_lshlrev_b32 v204, 16, v22
    v_and_b32 v205, 0xffff0000, v22
    v_add_f32 v24, v192, v193
    v_add_f32 v25, v194, v195
    v_add_f32 v24, v24, v196
    v_add_f32 v25, v25, v197
    v_add_f32 v24, v24, v198
    v_add_f32 v25, v25, v199
    v_add_f32 v24, v24, v200
    v_add_f32 v25, v25, v201
    v_add_f32 v24, v24, v202
    v_add_f32 v25, v25, v203
    v_add_f32 v24, v24, v204
    v_add_f32 v25, v25, v205
    v_add_f32 v24, v24, v25
    s_nop 1
    v_add_f32_dpp v24, v24, v24 row_ror:8 row_mask:0xf bank_mask:0xf
    s_nop 1
    v_add_f32_dpp v24, v24, v24 row_ror:4 row_mask:0xf bank_mask:0xf
    s_nop 1
    v_add_f32_dpp v24, v24, v24 row_ror:2 row_mask:0xf bank_mask:0xf
    v_mov_b32 v28, v24
    s_nop 1
    v_permlane16_swap_b32 v28, v24
    v_add_f32 v24, v28, v24
    v_mov_b32 v28, v24
    s_nop 1
    v_permlane32_swap_b32 v28, v24
    v_add_f32 v24, v28, v24
    s_mov_b32 s58, 0x3b124925
    v_mul_f32 v24, s58, v24
    v_sub_f32 v28, v192, v24
    v_sub_f32 v29, v193, v24
    v_mul_f32 v25, v28, v28
    v_mul_f32 v26, v29, v29
    v_sub_f32 v28, v194, v24
    v_sub_f32 v29, v195, v24
    v_fmac_f32 v25, v28, v28
    v_fmac_f32 v26, v29, v29
    v_sub_f32 v28, v196, v24
    v_sub_f32 v29, v197, v24
    v_fmac_f32 v25, v28, v28
    v_fmac_f32 v26, v29, v29
    v_sub_f32 v28, v198, v24
    v_sub_f32 v29, v199, v24
    v_fmac_f32 v25, v28, v28
    v_fmac_f32 v26, v29, v29
    v_sub_f32 v28, v200, v24
    v_sub_f32 v29, v201, v24
    v_fmac_f32 v25, v28, v28
    v_fmac_f32 v26, v29, v29
    v_sub_f32 v28, v202, v24
    v_sub_f32 v29, v203, v24
    v_fmac_f32 v25, v28, v28
    v_fmac_f32 v26, v29, v29
    v_sub_f32 v28, v204, v24
    v_sub_f32 v29, v205, v24
    v_fmac_f32 v25, v28, v28
    v_fmac_f32 v26, v29, v29
    v_add_f32 v25, v25, v26
    s_nop 1
    v_add_f32_dpp v25, v25, v25 row_ror:8 row_mask:0xf bank_mask:0xf
    s_nop 1
    v_add_f32_dpp v25, v25, v25 row_ror:4 row_mask:0xf bank_mask:0xf
    s_nop 1
    v_add_f32_dpp v25, v25, v25 row_ror:2 row_mask:0xf bank_mask:0xf
    v_mov_b32 v28, v25
    s_nop 1
    v_permlane16_swap_b32 v28, v25
    v_add_f32 v25, v28, v25
    v_mov_b32 v28, v25
    s_nop 1
    v_permlane32_swap_b32 v28, v25
    v_add_f32 v25, v28, v25
    v_mul_f32 v25, s58, v25
    v_cvt_pk_bf16_f32 v26, v24, v25
    v_lshlrev_b32 v24, 16, v26
    v_and_b32 v25, 0xffff0000, v26
    v_add_f32 v25, 0x3727c5ac, v25
    v_cvt_pk_bf16_f32 v25, v25, v25
    v_and_b32 v25, 0xffff0000, v25
    v_sqrt_f32 v25, v25
    s_nop 0
    v_cvt_pk_bf16_f32 v25, v25, v25
    v_and_b32 v25, 0xffff0000, v25
    v_rcp_f32 v26, v25
    v_sub_f32 v192, v192, v24
    v_sub_f32 v193, v193, v24
    v_cvt_pk_bf16_f32 v28, v192, v193
    v_lshlrev_b32 v192, 16, v28
    v_and_b32 v193, 0xffff0000, v28
    v_mul_f32 v28, v192, v26
    v_mul_f32 v29, v193, v26
    v_fma_f32 v192, -v28, v25, v192
    v_fma_f32 v193, -v29, v25, v193
    v_fmac_f32 v28, v192, v26
    v_fmac_f32 v29, v193, v26
    v_cvt_pk_bf16_f32 v16, v28, v29
    v_sub_f32 v194, v194, v24
    v_sub_f32 v195, v195, v24
    v_cvt_pk_bf16_f32 v28, v194, v195
    v_lshlrev_b32 v194, 16, v28
    v_and_b32 v195, 0xffff0000, v28
    v_mul_f32 v28, v194, v26
    v_mul_f32 v29, v195, v26
    v_fma_f32 v194, -v28, v25, v194
    v_fma_f32 v195, -v29, v25, v195
    v_fmac_f32 v28, v194, v26
    v_fmac_f32 v29, v195, v26
    v_cvt_pk_bf16_f32 v17, v28, v29
    v_sub_f32 v196, v196, v24
    v_sub_f32 v197, v197, v24
    v_cvt_pk_bf16_f32 v28, v196, v197
    v_lshlrev_b32 v196, 16, v28
    v_and_b32 v197, 0xffff0000, v28
    v_mul_f32 v28, v196, v26
    v_mul_f32 v29, v197, v26
    v_fma_f32 v196, -v28, v25, v196
    v_fma_f32 v197, -v29, v25, v197
    v_fmac_f32 v28, v196, v26
    v_fmac_f32 v29, v197, v26
    v_cvt_pk_bf16_f32 v18, v28, v29
    v_sub_f32 v198, v198, v24
    v_sub_f32 v199, v199, v24
    v_cvt_pk_bf16_f32 v28, v198, v199
    v_lshlrev_b32 v198, 16, v28
    v_and_b32 v199, 0xffff0000, v28
    v_mul_f32 v28, v198, v26
    v_mul_f32 v29, v199, v26
    v_fma_f32 v198, -v28, v25, v198
    v_fma_f32 v199, -v29, v25, v199
    v_fmac_f32 v28, v198, v26
    v_fmac_f32 v29, v199, v26
    v_cvt_pk_bf16_f32 v19, v28, v29
    v_sub_f32 v200, v200, v24
    v_sub_f32 v201, v201, v24
    v_cvt_pk_bf16_f32 v28, v200, v201
    v_lshlrev_b32 v200, 16, v28
    v_and_b32 v201, 0xffff0000, v28
    v_mul_f32 v28, v200, v26
    v_mul_f32 v29, v201, v26
    v_fma_f32 v200, -v28, v25, v200
    v_fma_f32 v201, -v29, v25, v201
    v_fmac_f32 v28, v200, v26
    v_fmac_f32 v29, v201, v26
    v_cvt_pk_bf16_f32 v20, v28, v29
    v_sub_f32 v202, v202, v24
    v_sub_f32 v203, v203, v24
    v_cvt_pk_bf16_f32 v28, v202, v203
    v_lshlrev_b32 v202, 16, v28
    v_and_b32 v203, 0xffff0000, v28
    v_mul_f32 v28, v202, v26
    v_mul_f32 v29, v203, v26
    v_fma_f32 v202, -v28, v25, v202
    v_fma_f32 v203, -v29, v25, v203
    v_fmac_f32 v28, v202, v26
    v_fmac_f32 v29, v203, v26
    v_cvt_pk_bf16_f32 v21, v28, v29
    v_sub_f32 v204, v204, v24
    v_sub_f32 v205, v205, v24
    v_cvt_pk_bf16_f32 v28, v204, v205
    v_lshlrev_b32 v204, 16, v28
    v_and_b32 v205, 0xffff0000, v28
    v_mul_f32 v28, v204, v26
    v_mul_f32 v29, v205, v26
    v_fma_f32 v204, -v28, v25, v204
    v_fma_f32 v205, -v29, v25, v205
    v_fmac_f32 v28, v204, v26
    v_fmac_f32 v29, v205, v26
    v_cvt_pk_bf16_f32 v22, v28, v29
    v_lshrrev_b32 v28, 1, v0
    v_mul_u32_u24 v28, 28, v28
    v_and_b32 v29, 1, v0
    v_lshlrev_b32 v29, 10, v29
    v_add3_u32 v28, v28, v29, s59
    ds_write_b32 v28, v16 offset:2048
    ds_write_b32 v28, v17 offset:2052
    ds_write_b32 v28, v18 offset:2056
    ds_write_b32 v28, v19 offset:2060
    ds_write_b32 v28, v20 offset:2064
    ds_write_b32 v28, v21 offset:2068
    ds_write_b32 v28, v22 offset:2072
    v_bfe_u32 v11, v0, 3, 1
    v_lshlrev_b32 v11, 10, v11
    v_lshrrev_b32 v29, 4, v0
    v_mul_u32_u24 v29, 56, v29
    v_add3_u32 v11, v11, v29, s59
    s_waitcnt lgkmcnt(0)
    v_lshrrev_b32 v1, 3, v0
    v_mul_u32_u24 v1, 50176, v1
    v_and_b32 v10, 7, v0
    v_lshl_add_u32 v1, v10, 4, v1
    s_mov_b32 s65, 0
    s_mov_b32 s36, s16
    s_mov_b32 s37, s17
    s_mov_b32 s38, 1605632
    s_mov_b32 s39, 0x00020000
    s_mov_b32 s48, s18
    s_mov_b32 s49, s19
    s_mov_b32 s50, 1605632
    s_mov_b32 s51, 0x00020000
    v_mov_b32 v12, 0
    v_mov_b32 v13, 0
    v_mov_b32 v14, 0
    v_mov_b32 v15, 0
    v_mov_b32 v16, 0
    v_mov_b32 v17, 0
    v_mov_b32 v18, 0
    v_mov_b32 v19, 0
    v_mov_b32 v20, 0
    v_mov_b32 v21, 0
    v_mov_b32 v22, 0
    v_mov_b32 v23, 0
    v_mov_b32 v24, 0
    v_mov_b32 v25, 0
    v_mov_b32 v26, 0
    v_mov_b32 v27, 0
L_f_blk:
    s_mul_i32 s58, s65, 401408
    s_lshl_b32 s59, s35, 7
    s_add_u32 s58, s58, s59
    buffer_load_dwordx4 v[64:67], v1, s[36:39], s58 offen nt
    buffer_load_dwordx4 v[120:123], v1, s[48:51], s58 offen nt
    s_add_u32 s58, s58, 3584
    buffer_load_dwordx4 v[68:71], v1, s[36:39], s58 offen nt
    buffer_load_dwordx4 v[124:127], v1, s[48:51], s58 offen nt
    s_add_u32 s58, s58, 3584
    buffer_load_dwordx4 v[72:75], v1, s[36:39], s58 offen nt
    buffer_load_dwordx4 v[128:131], v1, s[48:51], s58 offen nt
    s_add_u32 s58, s58, 3584
    buffer_load_dwordx4 v[76:79], v1, s[36:39], s58 offen nt
    buffer_load_dwordx4 v[132:135], v1, s[48:51], s58 offen nt
    s_add_u32 s58, s58, 3584
    buffer_load_dwordx4 v[80:83], v1, s[36:39], s58 offen nt
    buffer_load_dwordx4 v[136:139], v1, s[48:51], s58 offen nt
    s_add_u32 s58, s58, 3584
    buffer_load_dwordx4 v[84:87], v1, s[36:39], s58 offen nt
    buffer_load_dwordx4 v[140:143], v1, s[48:51], s58 offen nt
    s_add_u32 s58, s58, 3584
    buffer_load_dwordx4 v[88:91], v1, s[36:39], s58 offen nt
    buffer_load_dwordx4 v[144:147], v1, s[48:51], s58 offen nt
    s_add_u32 s58, s58, 3584
    buffer_load_dwordx4 v[92:95], v1, s[36:39], s58 offen nt
    buffer_load_dwordx4 v[148:151], v1, s[48:51], s58 offen nt
    s_add_u32 s58, s58, 3584
    buffer_load_dwordx4 v[96:99], v1, s[36:39], s58 offen nt
    buffer_load_dwordx4 v[152:155], v1, s[48:51], s58 offen nt
    s_add_u32 s58, s58, 3584
    buffer_load_dwordx4 v[100:103], v1, s[36:39], s58 offen nt
    buffer_load_dwordx4 v[156:159], v1, s[48:51], s58 offen nt
    s_add_u32 s58, s58, 3584
    buffer_load_dwordx4 v[104:107], v1, s[36:39], s58 offen nt
    buffer_load_dwordx4 v[160:163], v1, s[48:51], s58 offen nt
    s_add_u32 s58, s58, 3584
    buffer_load_dwordx4 v[108:111], v1, s[36:39], s58 offen nt
    buffer_load_dwordx4 v[164:167], v1, s[48:51], s58 offen nt
    s_add_u32 s58, s58, 3584
    buffer_load_dwordx4 v[112:115], v1, s[36:39], s58 offen nt
    buffer_load_dwordx4 v[168:171], v1, s[48:51], s58 offen nt
    s_add_u32 s58, s58, 3584
    buffer_load_dwordx4 v[116:119], v1, s[36:39], s58 offen nt
    buffer_load_dwordx4 v[172:175], v1, s[48:51], s58 offen nt
    s_mul_i32 s58, s65, 224
    v_add_u32 v10, s58, v11
    ds_read_b64 v[32:33], v10 offset:2048
    ds_read_b64 v[34:35], v10 offset:2056
    ds_read_b64 v[36:37], v10 offset:2064
    ds_read_b64 v[38:39], v10 offset:2072
    ds_read_b64 v[40:41], v10 offset:2080
    ds_read_b64 v[42:43], v10 offset:2088
    ds_read_b64 v[44:45], v10 offset:2096
    s_waitcnt lgkmcnt(0)
    v_perm_b32 v52, v32, v32, s74
    v_and_b32 v48, v52, v4
    v_and_b32 v49, v52, v5
    v_and_b32 v50, v52, v6
    v_and_b32 v51, v52, v7
    s_waitcnt vmcnt(24)
    s_nop 0
    v_mfma_f32_16x16x32_bf16 v[12:15], v[48:51], v[64:67], v[12:15]
    v_mfma_f32_16x16x32_bf16 v[20:23], v[48:51], v[120:123], v[20:23]
    v_perm_b32 v60, v39, v39, s74
    v_and_b32 v56, v60, v4
    v_and_b32 v57, v60, v5
    v_and_b32 v58, v60, v6
    v_and_b32 v59, v60, v7
    s_nop 1
    v_mfma_f32_16x16x32_bf16 v[16:19], v[56:59], v[64:67], v[16:19]
    v_mfma_f32_16x16x32_bf16 v[24:27], v[56:59], v[120:123], v[24:27]
    v_perm_b32 v52, v32, v32, s75
    v_and_b32 v48, v52, v4
    v_and_b32 v49, v52, v5
    v_and_b32 v50, v52, v6
    v_and_b32 v51, v52, v7
    s_nop 1
    v_mfma_f32_16x16x32_bf16 v[12:15], v[48:51], v[68:71], v[12:15]
    v_mfma_f32_16x16x32_bf16 v[20:23], v[48:51], v[124:127], v[20:23]
    v_perm_b32 v60, v39, v39, s75
    v_and_b32 v56, v60, v4
    v_and_b32 v57, v60, v5
    v_and_b32 v58, v60, v6
    v_and_b32 v59, v60, v7
    s_nop 1
    v_mfma_f32_16x16x32_bf16 v[16:19], v[56:59], v[68:71], v[16:19]
    v_mfma_f32_16x16x32_bf16 v[24:27], v[56:59], v[124:127], v[24:27]
    v_perm_b32 v52, v33, v33, s74
    v_and_b32 v48, v52, v4
    v_and_b32 v49, v52, v5
    v_and_b32 v50, v52, v6
    v_and_b32 v51, v52, v7
    s_waitcnt vmcnt(20)
    s_nop 0
    v_mfma_f32_16x16x32_bf16 v[12:15], v[48:51], v[72:75], v[12:15]
    v_mfma_f32_16x16x32_bf16 v[20:23], v[48:51], v[128:131], v[20:23]
    v_perm_b32 v60, v40, v40, s74
    v_and_b32 v56, v60, v4
    v_and_b32 v57, v60, v5
    v_and_b32 v58, v60, v6
    v_and_b32 v59, v60, v7
    s_nop 1
    v_mfma_f32_16x16x32_bf16 v[16:19], v[56:59], v[72:75], v[16:19]
    v_mfma_f32_16x16x32_bf16 v[24:27], v[56:59], v[128:131], v[24:27]
    v_perm_b32 v52, v33, v33, s75
    v_and_b32 v48, v52, v4
    v_and_b32 v49, v52, v5
    v_and_b32 v50, v52, v6
    v_and_b32 v51, v52, v7
    s_nop 1
    v_mfma_f32_16x16x32_bf16 v[12:15], v[48:51], v[76:79], v[12:15]
    v_mfma_f32_16x16x32_bf16 v[20:23], v[48:51], v[132:135], v[20:23]
    v_perm_b32 v60, v40, v40, s75
    v_and_b32 v56, v60, v4
    v_and_b32 v57, v60, v5
    v_and_b32 v58, v60, v6
    v_and_b32 v59, v60, v7
    s_nop 1
    v_mfma_f32_16x16x32_bf16 v[16:19], v[56:59], v[76:79], v[16:19]
    v_mfma_f32_16x16x32_bf16 v[24:27], v[56:59], v[132:135], v[24:27]
    v_perm_b32 v52, v34, v34, s74
    v_and_b32 v48, v52, v4
    v_and_b32 v49, v52, v5
    v_and_b32 v50, v52, v6
    v_and_b32 v51, v52, v7
    s_waitcnt vmcnt(16)
    s_nop 0
    v_mfma_f32_16x16x32_bf16 v[12:15], v[48:51], v[80:83], v[12:15]
    v_mfma_f32_16x16x32_bf16 v[20:23], v[48:51], v[136:139], v[20:23]
    v_perm_b32 v60, v41, v41, s74
    v_and_b32 v56, v60, v4
    v_and_b32 v57, v60, v5
    v_and_b32 v58, v60, v6
    v_and_b32 v59, v60, v7
    s_nop 1
    v_mfma_f32_16x16x32_bf16 v[16:19], v[56:59], v[80:83], v[16:19]
    v_mfma_f32_16x16x32_bf16 v[24:27], v[56:59], v[136:139], v[24:27]
    v_perm_b32 v52, v34, v34, s75
    v_and_b32 v48, v52, v4
    v_and_b32 v49, v52, v5
    v_and_b32 v50, v52, v6
    v_and_b32 v51, v52, v7
    s_nop 1
    v_mfma_f32_16x16x32_bf16 v[12:15], v[48:51], v[84:87], v[12:15]
    v_mfma_f32_16x16x32_bf16 v[20:23], v[48:51], v[140:143], v[20:23]
    v_perm_b32 v60, v41, v41, s75
    v_and_b32 v56, v60, v4
    v_and_b32 v57, v60, v5
    v_and_b32 v58, v60, v6
    v_and_b32 v59, v60, v7
    s_nop 1
    v_mfma_f32_16x16x32_bf16 v[16:19], v[56:59], v[84:87], v[16:19]
    v_mfma_f32_16x16x32_bf16 v[24:27], v[56:59], v[140:143], v[24:27]
    v_perm_b32 v52, v35, v35, s74
    v_and_b32 v48, v52, v4
    v_and_b32 v49, v52, v5
    v_and_b32 v50, v52, v6
    v_and_b32 v51, v52, v7
    s_waitcnt vmcnt(12)
    s_nop 0
    v_mfma_f32_16x16x32_bf16 v[12:15], v[48:51], v[88:91], v[12:15]
    v_mfma_f32_16x16x32_bf16 v[20:23], v[48:51], v[144:147], v[20:23]
    v_perm_b32 v60, v42, v42, s74
    v_and_b32 v56, v60, v4
    v_and_b32 v57, v60, v5
    v_and_b32 v58, v60, v6
    v_and_b32 v59, v60, v7
    s_nop 1
    v_mfma_f32_16x16x32_bf16 v[16:19], v[56:59], v[88:91], v[16:19]
    v_mfma_f32_16x16x32_bf16 v[24:27], v[56:59], v[144:147], v[24:27]
    v_perm_b32 v52, v35, v35, s75
    v_and_b32 v48, v52, v4
    v_and_b32 v49, v52, v5
    v_and_b32 v50, v52, v6
    v_and_b32 v51, v52, v7
    s_nop 1
    v_mfma_f32_16x16x32_bf16 v[12:15], v[48:51], v[92:95], v[12:15]
    v_mfma_f32_16x16x32_bf16 v[20:23], v[48:51], v[148:151], v[20:23]
    v_perm_b32 v60, v42, v42, s75
    v_and_b32 v56, v60, v4
    v_and_b32 v57, v60, v5
    v_and_b32 v58, v60, v6
    v_and_b32 v59, v60, v7
    s_nop 1
    v_mfma_f32_16x16x32_bf16 v[16:19], v[56:59], v[92:95], v[16:19]
    v_mfma_f32_16x16x32_bf16 v[24:27], v[56:59], v[148:151], v[24:27]
    v_perm_b32 v52, v36, v36, s74
    v_and_b32 v48, v52, v4
    v_and_b32 v49, v52, v5
    v_and_b32 v50, v52, v6
    v_and_b32 v51, v52, v7
    s_waitcnt vmcnt(8)
    s_nop 0
    v_mfma_f32_16x16x32_bf16 v[12:15], v[48:51], v[96:99], v[12:15]
    v_mfma_f32_16x16x32_bf16 v[20:23], v[48:51], v[152:155], v[20:23]
    v_perm_b32 v60, v43, v43, s74
    v_and_b32 v56, v60, v4
    v_and_b32 v57, v60, v5
    v_and_b32 v58, v60, v6
    v_and_b32 v59, v60, v7
    s_nop 1
    v_mfma_f32_16x16x32_bf16 v[16:19], v[56:59], v[96:99], v[16:19]
    v_mfma_f32_16x16x32_bf16 v[24:27], v[56:59], v[152:155], v[24:27]
    v_perm_b32 v52, v36, v36, s75
    v_and_b32 v48, v52, v4
    v_and_b32 v49, v52, v5
    v_and_b32 v50, v52, v6
    v_and_b32 v51, v52, v7
    s_nop 1
    v_mfma_f32_16x16x32_bf16 v[12:15], v[48:51], v[100:103], v[12:15]
    v_mfma_f32_16x16x32_bf16 v[20:23], v[48:51], v[156:159], v[20:23]
    v_perm_b32 v60, v43, v43, s75
    v_and_b32 v56, v60, v4
    v_and_b32 v57, v60, v5
    v_and_b32 v58, v60, v6
    v_and_b32 v59, v60, v7
    s_nop 1
    v_mfma_f32_16x16x32_bf16 v[16:19], v[56:59], v[100:103], v[16:19]
    v_mfma_f32_16x16x32_bf16 v[24:27], v[56:59], v[156:159], v[24:27]
    v_perm_b32 v52, v37, v37, s74
    v_and_b32 v48, v52, v4
    v_and_b32 v49, v52, v5
    v_and_b32 v50, v52, v6
    v_and_b32 v51, v52, v7
    s_waitcnt vmcnt(4)
    s_nop 0
    v_mfma_f32_16x16x32_bf16 v[12:15], v[48:51], v[104:107], v[12:15]
    v_mfma_f32_16x16x32_bf16 v[20:23], v[48:51], v[160:163], v[20:23]
    v_perm_b32 v60, v44, v44, s74
    v_and_b32 v56, v60, v4
    v_and_b32 v57, v60, v5
    v_and_b32 v58, v60, v6
    v_and_b32 v59, v60, v7
    s_nop 1
    v_mfma_f32_16x16x32_bf16 v[16:19], v[56:59], v[104:107], v[16:19]
    v_mfma_f32_16x16x32_bf16 v[24:27], v[56:59], v[160:163], v[24:27]
    v_perm_b32 v52, v37, v37, s75
    v_and_b32 v48, v52, v4
    v_and_b32 v49, v52, v5
    v_and_b32 v50, v52, v6
    v_and_b32 v51, v52, v7
    s_nop 1
    v_mfma_f32_16x16x32_bf16 v[12:15], v[48:51], v[108:111], v[12:15]
    v_mfma_f32_16x16x32_bf16 v[20:23], v[48:51], v[164:167], v[20:23]
    v_perm_b32 v60, v44, v44, s75
    v_and_b32 v56, v60, v4
    v_and_b32 v57, v60, v5
    v_and_b32 v58, v60, v6
    v_and_b32 v59, v60, v7
    s_nop 1
    v_mfma_f32_16x16x32_bf16 v[16:19], v[56:59], v[108:111], v[16:19]
    v_mfma_f32_16x16x32_bf16 v[24:27], v[56:59], v[164:167], v[24:27]
    v_perm_b32 v52, v38, v38, s74
    v_and_b32 v48, v52, v4
    v_and_b32 v49, v52, v5
    v_and_b32 v50, v52, v6
    v_and_b32 v51, v52, v7
    s_waitcnt vmcnt(0)
    s_nop 0
    v_mfma_f32_16x16x32_bf16 v[12:15], v[48:51], v[112:115], v[12:15]
    v_mfma_f32_16x16x32_bf16 v[20:23], v[48:51], v[168:171], v[20:23]
    v_perm_b32 v60, v45, v45, s74
    v_and_b32 v56, v60, v4
    v_and_b32 v57, v60, v5
    v_and_b32 v58, v60, v6
    v_and_b32 v59, v60, v7
    s_nop 1
    v_mfma_f32_16x16x32_bf16 v[16:19], v[56:59], v[112:115], v[16:19]
    v_mfma_f32_16x16x32_bf16 v[24:27], v[56:59], v[168:171], v[24:27]
    v_perm_b32 v52, v38, v38, s75
    v_and_b32 v48, v52, v4
    v_and_b32 v49, v52, v5
    v_and_b32 v50, v52, v6
    v_and_b32 v51, v52, v7
    s_nop 1
    v_mfma_f32_16x16x32_bf16 v[12:15], v[48:51], v[116:119], v[12:15]
    v_mfma_f32_16x16x32_bf16 v[20:23], v[48:51], v[172:175], v[20:23]
    v_perm_b32 v60, v45, v45, s75
    v_and_b32 v56, v60, v4
    v_and_b32 v57, v60, v5
    v_and_b32 v58, v60, v6
    v_and_b32 v59, v60, v7
    s_nop 1
    v_mfma_f32_16x16x32_bf16 v[16:19], v[56:59], v[116:119], v[16:19]
    v_mfma_f32_16x16x32_bf16 v[24:27], v[56:59], v[172:175], v[24:27]
    s_add_u32 s65, s65, 1
    s_cmp_lg_u32 s65, 4
    s_cbranch_scc1 L_f_blk
    v_lshrrev_b32 v3, 4, v0
    v_and_b32 v2, 15, v0
    s_mov_b32 s36, s20
    s_mov_b32 s37, s21
    s_mov_b32 s38, 1605632
    s_mov_b32 s39, 0x00020000
    v_mul_u32_u24 v30, 14336, v3
    v_lshl_add_u32 v30, v2, 4, v30
    s_mul_i32 s64, s35, 57344
    s_mov_b32 s58, s64
    buffer_load_dwordx4 v[64:67], v30, s[36:39], s58 offen offset:0 nt
    buffer_load_dwordx4 v[128:131], v30, s[36:39], s58 offen offset:256 nt
    buffer_load_dwordx4 v[68:71], v30, s[36:39], s58 offen offset:896 nt
    buffer_load_dwordx4 v[132:135], v30, s[36:39], s58 offen offset:1152 nt
    buffer_load_dwordx4 v[72:75], v30, s[36:39], s58 offen offset:1792 nt
    buffer_load_dwordx4 v[136:139], v30, s[36:39], s58 offen offset:2048 nt
    buffer_load_dwordx4 v[76:79], v30, s[36:39], s58 offen offset:2688 nt
    buffer_load_dwordx4 v[140:143], v30, s[36:39], s58 offen offset:2944 nt
    s_add_u32 s58, s58, 3584
    buffer_load_dwordx4 v[80:83], v30, s[36:39], s58 offen offset:0 nt
    buffer_load_dwordx4 v[144:147], v30, s[36:39], s58 offen offset:256 nt
    buffer_load_dwordx4 v[84:87], v30, s[36:39], s58 offen offset:896 nt
    buffer_load_dwordx4 v[148:151], v30, s[36:39], s58 offen offset:1152 nt
    buffer_load_dwordx4 v[88:91], v30, s[36:39], s58 offen offset:1792 nt
    buffer_load_dwordx4 v[152:155], v30, s[36:39], s58 offen offset:2048 nt
    buffer_load_dwordx4 v[92:95], v30, s[36:39], s58 offen offset:2688 nt
    buffer_load_dwordx4 v[156:159], v30, s[36:39], s58 offen offset:2944 nt
    s_add_u32 s58, s58, 3584
    buffer_load_dwordx4 v[96:99], v30, s[36:39], s58 offen offset:0 nt
    buffer_load_dwordx4 v[160:163], v30, s[36:39], s58 offen offset:256 nt
    buffer_load_dwordx4 v[100:103], v30, s[36:39], s58 offen offset:896 nt
    buffer_load_dwordx4 v[164:167], v30, s[36:39], s58 offen offset:1152 nt
    buffer_load_dwordx4 v[104:107], v30, s[36:39], s58 offen offset:1792 nt
    buffer_load_dwordx4 v[168:171], v30, s[36:39], s58 offen offset:2048 nt
    buffer_load_dwordx4 v[108:111], v30, s[36:39], s58 offen offset:2688 nt
    buffer_load_dwordx4 v[172:175], v30, s[36:39], s58 offen offset:2944 nt
    s_add_u32 s58, s58, 3584
    buffer_load_dwordx4 v[112:115], v30, s[36:39], s58 offen offset:0 nt
    buffer_load_dwordx4 v[176:179], v30, s[36:39], s58 offen offset:256 nt
    buffer_load_dwordx4 v[116:119], v30, s[36:39], s58 offen offset:896 nt
    buffer_load_dwordx4 v[180:183], v30, s[36:39], s58 offen offset:1152 nt
    buffer_load_dwordx4 v[120:123], v30, s[36:39], s58 offen offset:1792 nt
    buffer_load_dwordx4 v[184:187], v30, s[36:39], s58 offen offset:2048 nt
    buffer_load_dwordx4 v[124:127], v30, s[36:39], s58 offen offset:2688 nt
    buffer_load_dwordx4 v[188:191], v30, s[36:39], s58 offen offset:2944 nt
    v_add_f32_dpp v208, v16, v12 row_ror:8 row_mask:0xf bank_mask:0xf
    v_add_f32_dpp v209, v17, v13 row_ror:8 row_mask:0xf bank_mask:0xf
    v_add_f32_dpp v210, v18, v14 row_ror:8 row_mask:0xf bank_mask:0xf
    v_add_f32_dpp v211, v19, v15 row_ror:8 row_mask:0xf bank_mask:0xf
    v_add_f32_dpp v224, v24, v20 row_ror:8 row_mask:0xf bank_mask:0xf
    v_add_f32_dpp v225, v25, v21 row_ror:8 row_mask:0xf bank_mask:0xf
    v_add_f32_dpp v226, v26, v22 row_ror:8 row_mask:0xf bank_mask:0xf
    v_add_f32_dpp v227, v27, v23 row_ror:8 row_mask:0xf bank_mask:0xf
    v_cvt_pk_bf16_f32 v10, v208, v209
    v_lshlrev_b32 v208, 16, v10
    v_and_b32 v209, 0xffff0000, v10
    v_cvt_pk_bf16_f32 v10, v210, v211
    v_lshlrev_b32 v210, 16, v10
    v_and_b32 v211, 0xffff0000, v10
    v_cvt_pk_bf16_f32 v10, v224, v225
    v_lshlrev_b32 v224, 16, v10
    v_and_b32 v225, 0xffff0000, v10
    v_cvt_pk_bf16_f32 v10, v226, v227
    v_lshlrev_b32 v226, 16, v10
    v_and_b32 v227, 0xffff0000, v10
    s_mov_b32 s58, 0xbfb8aa3b
    v_mul_f32 v212, s58, v208
    v_mul_f32 v213, s58, v209
    v_mul_f32 v214, s58, v210
    v_mul_f32 v215, s58, v211
    v_exp_f32 v212, v212
    v_exp_f32 v213, v213
    v_exp_f32 v214, v214
    v_exp_f32 v215, v215
    v_add_f32 v212, 1.0, v212
    v_add_f32 v213, 1.0, v213
    v_add_f32 v214, 1.0, v214
    v_add_f32 v215, 1.0, v215
    v_rcp_f32 v212, v212
    v_rcp_f32 v213, v213
    v_rcp_f32 v214, v214
    v_rcp_f32 v215, v215
    v_mul_f32 v208, v208, v212
    v_mul_f32 v209, v209, v213
    v_mul_f32 v210, v210, v214
    v_mul_f32 v211, v211, v215
    v_cvt_pk_bf16_f32 v10, v208, v209
    v_lshlrev_b32 v208, 16, v10
    v_and_b32 v209, 0xffff0000, v10
    v_cvt_pk_bf16_f32 v10, v210, v211
    v_lshlrev_b32 v210, 16, v10
    v_and_b32 v211, 0xffff0000, v10
    v_mul_f32 v208, v208, v224
    v_mul_f32 v209, v209, v225
    v_mul_f32 v210, v210, v226
    v_mul_f32 v211, v211, v227
    v_cvt_pk_bf16_f32 v12, v208, v209
    v_cvt_pk_bf16_f32 v13, v210, v211
    v_lshrrev_b32 v1, 5, v0
    v_lshlrev_b32 v1, 7, v1
    v_and_b32 v10, 7, v0
    v_lshl_add_u32 v1, v10, 4, v1
    v_and_b32 v10, 1, v3
    v_lshl_add_u32 v1, v10, 3, v1
    v_and_b32 v10, 8, v0
    v_lshl_add_u32 v1, v10, 5, v1
    ds_write_b64 v1, v[12:13] offset:1280
    v_bfe_u32 v1, v0, 3, 1
    v_lshlrev_b32 v1, 7, v1
    v_lshl_add_u32 v1, v3, 5, v1
    s_waitcnt lgkmcnt(0)
    ds_read_b128 v[32:35], v1 offset:1280
    ds_read_b128 v[36:39], v1 offset:1296
    v_lshrrev_b32 v11, 5, v0
    v_lshlrev_b32 v11, 11, v11
    v_lshl_add_u32 v11, v2, 5, v11
    v_and_b32 v10, 1, v3
    v_lshl_add_u32 v11, v10, 4, v11
    s_lshl_b32 s65, s35, 12
    s_add_u32 s65, s65, 4194304
    s_mov_b32 s76, 400000
L_lw_64:
    ds_read_b32 v10, v8 offset:0
    s_waitcnt lgkmcnt(0)
    v_readfirstlane_b32 s58, v10
    s_nop 0
    s_cmp_lg_u32 s58, 0
    s_cbranch_scc1 L_lwd_65
    s_sleep 8
    s_sub_u32 s76, s76, 1
    s_cmp_gt_i32 s76, 0
    s_cbranch_scc1 L_lw_64
L_lwd_65:
    s_mov_b32 s66, 2
L_f_w2:
    s_waitcnt vmcnt(0) lgkmcnt(0)
    v_perm_b32 v52, v32, v32, s74
    v_and_b32 v48, v52, v4
    v_and_b32 v49, v52, v5
    v_and_b32 v50, v52, v6
    v_and_b32 v51, v52, v7
    s_nop 1
    v_mfma_f32_16x16x32_bf16 v[12:15], v[48:51], v[64:67], 0
    v_mfma_f32_16x16x32_bf16 v[16:19], v[48:51], v[128:131], 0
    v_perm_b32 v60, v32, v32, s75
    v_and_b32 v56, v60, v4
    v_and_b32 v57, v60, v5
    v_and_b32 v58, v60, v6
    v_and_b32 v59, v60, v7
    s_nop 1
    v_mfma_f32_16x16x32_bf16 v[12:15], v[56:59], v[68:71], v[12:15]
    v_mfma_f32_16x16x32_bf16 v[16:19], v[56:59], v[132:135], v[16:19]
    v_perm_b32 v52, v33, v33, s74
    v_and_b32 v48, v52, v4
    v_and_b32 v49, v52, v5
    v_and_b32 v50, v52, v6
    v_and_b32 v51, v52, v7
    s_nop 1
    v_mfma_f32_16x16x32_bf16 v[12:15], v[48:51], v[72:75], v[12:15]
    v_mfma_f32_16x16x32_bf16 v[16:19], v[48:51], v[136:139], v[16:19]
    v_perm_b32 v60, v33, v33, s75
    v_and_b32 v56, v60, v4
    v_and_b32 v57, v60, v5
    v_and_b32 v58, v60, v6
    v_and_b32 v59, v60, v7
    s_nop 1
    v_mfma_f32_16x16x32_bf16 v[12:15], v[56:59], v[76:79], v[12:15]
    v_mfma_f32_16x16x32_bf16 v[16:19], v[56:59], v[140:143], v[16:19]
    v_perm_b32 v52, v34, v34, s74
    v_and_b32 v48, v52, v4
    v_and_b32 v49, v52, v5
    v_and_b32 v50, v52, v6
    v_and_b32 v51, v52, v7
    s_nop 1
    v_mfma_f32_16x16x32_bf16 v[12:15], v[48:51], v[80:83], v[12:15]
    v_mfma_f32_16x16x32_bf16 v[16:19], v[48:51], v[144:147], v[16:19]
    v_perm_b32 v60, v34, v34, s75
    v_and_b32 v56, v60, v4
    v_and_b32 v57, v60, v5
    v_and_b32 v58, v60, v6
    v_and_b32 v59, v60, v7
    s_nop 1
    v_mfma_f32_16x16x32_bf16 v[12:15], v[56:59], v[84:87], v[12:15]
    v_mfma_f32_16x16x32_bf16 v[16:19], v[56:59], v[148:151], v[16:19]
    v_perm_b32 v52, v35, v35, s74
    v_and_b32 v48, v52, v4
    v_and_b32 v49, v52, v5
    v_and_b32 v50, v52, v6
    v_and_b32 v51, v52, v7
    s_nop 1
    v_mfma_f32_16x16x32_bf16 v[12:15], v[48:51], v[88:91], v[12:15]
    v_mfma_f32_16x16x32_bf16 v[16:19], v[48:51], v[152:155], v[16:19]
    v_perm_b32 v60, v35, v35, s75
    v_and_b32 v56, v60, v4
    v_and_b32 v57, v60, v5
    v_and_b32 v58, v60, v6
    v_and_b32 v59, v60, v7
    s_nop 1
    v_mfma_f32_16x16x32_bf16 v[12:15], v[56:59], v[92:95], v[12:15]
    v_mfma_f32_16x16x32_bf16 v[16:19], v[56:59], v[156:159], v[16:19]
    v_perm_b32 v52, v36, v36, s74
    v_and_b32 v48, v52, v4
    v_and_b32 v49, v52, v5
    v_and_b32 v50, v52, v6
    v_and_b32 v51, v52, v7
    s_nop 1
    v_mfma_f32_16x16x32_bf16 v[12:15], v[48:51], v[96:99], v[12:15]
    v_mfma_f32_16x16x32_bf16 v[16:19], v[48:51], v[160:163], v[16:19]
    v_perm_b32 v60, v36, v36, s75
    v_and_b32 v56, v60, v4
    v_and_b32 v57, v60, v5
    v_and_b32 v58, v60, v6
    v_and_b32 v59, v60, v7
    s_nop 1
    v_mfma_f32_16x16x32_bf16 v[12:15], v[56:59], v[100:103], v[12:15]
    v_mfma_f32_16x16x32_bf16 v[16:19], v[56:59], v[164:167], v[16:19]
    v_perm_b32 v52, v37, v37, s74
    v_and_b32 v48, v52, v4
    v_and_b32 v49, v52, v5
    v_and_b32 v50, v52, v6
    v_and_b32 v51, v52, v7
    s_nop 1
    v_mfma_f32_16x16x32_bf16 v[12:15], v[48:51], v[104:107], v[12:15]
    v_mfma_f32_16x16x32_bf16 v[16:19], v[48:51], v[168:171], v[16:19]
    v_perm_b32 v60, v37, v37, s75
    v_and_b32 v56, v60, v4
    v_and_b32 v57, v60, v5
    v_and_b32 v58, v60, v6
    v_and_b32 v59, v60, v7
    s_nop 1
    v_mfma_f32_16x16x32_bf16 v[12:15], v[56:59], v[108:111], v[12:15]
    v_mfma_f32_16x16x32_bf16 v[16:19], v[56:59], v[172:175], v[16:19]
    v_perm_b32 v52, v38, v38, s74
    v_and_b32 v48, v52, v4
    v_and_b32 v49, v52, v5
    v_and_b32 v50, v52, v6
    v_and_b32 v51, v52, v7
    s_nop 1
    v_mfma_f32_16x16x32_bf16 v[12:15], v[48:51], v[112:115], v[12:15]
    v_mfma_f32_16x16x32_bf16 v[16:19], v[48:51], v[176:179], v[16:19]
    v_perm_b32 v60, v38, v38, s75
    v_and_b32 v56, v60, v4
    v_and_b32 v57, v60, v5
    v_and_b32 v58, v60, v6
    v_and_b32 v59, v60, v7
    s_nop 1
    v_mfma_f32_16x16x32_bf16 v[12:15], v[56:59], v[116:119], v[12:15]
    v_mfma_f32_16x16x32_bf16 v[16:19], v[56:59], v[180:183], v[16:19]
    v_perm_b32 v52, v39, v39, s74
    v_and_b32 v48, v52, v4
    v_and_b32 v49, v52, v5
    v_and_b32 v50, v52, v6
    v_and_b32 v51, v52, v7
    s_nop 1
    v_mfma_f32_16x16x32_bf16 v[12:15], v[48:51], v[120:123], v[12:15]
    v_mfma_f32_16x16x32_bf16 v[16:19], v[48:51], v[184:187], v[16:19]
    v_perm_b32 v60, v39, v39, s75
    v_and_b32 v56, v60, v4
    v_and_b32 v57, v60, v5
    v_and_b32 v58, v60, v6
    v_and_b32 v59, v60, v7
    s_nop 1
    v_mfma_f32_16x16x32_bf16 v[12:15], v[56:59], v[124:127], v[12:15]
    v_mfma_f32_16x16x32_bf16 v[16:19], v[56:59], v[188:191], v[16:19]
    s_nop 6
    v_min_u32 v12, -2, v12
    v_min_u32 v13, -2, v13
    v_min_u32 v14, -2, v14
    v_min_u32 v15, -2, v15
    v_min_u32 v16, -2, v16
    v_min_u32 v17, -2, v17
    v_min_u32 v18, -2, v18
    v_min_u32 v19, -2, v19
    buffer_store_dwordx4 v[12:15], v11, s[44:47], s65 offen sc1
    buffer_store_dwordx4 v[16:19], v11, s[44:47], s65 offen offset:512 sc1
    s_sub_u32 s66, s66, 1
    s_cmp_eq_u32 s66, 0
    s_cbranch_scc1 L_tailw
    s_add_u32 s64, s64, 512
    s_add_u32 s65, s65, 1024
    s_mov_b32 s58, s64
    buffer_load_dwordx4 v[64:67], v30, s[36:39], s58 offen offset:0 nt
    buffer_load_dwordx4 v[128:131], v30, s[36:39], s58 offen offset:256 nt
    buffer_load_dwordx4 v[68:71], v30, s[36:39], s58 offen offset:896 nt
    buffer_load_dwordx4 v[132:135], v30, s[36:39], s58 offen offset:1152 nt
    buffer_load_dwordx4 v[72:75], v30, s[36:39], s58 offen offset:1792 nt
    buffer_load_dwordx4 v[136:139], v30, s[36:39], s58 offen offset:2048 nt
    buffer_load_dwordx4 v[76:79], v30, s[36:39], s58 offen offset:2688 nt
    buffer_load_dwordx4 v[140:143], v30, s[36:39], s58 offen offset:2944 nt
    s_add_u32 s58, s58, 3584
    buffer_load_dwordx4 v[80:83], v30, s[36:39], s58 offen offset:0 nt
    buffer_load_dwordx4 v[144:147], v30, s[36:39], s58 offen offset:256 nt
    buffer_load_dwordx4 v[84:87], v30, s[36:39], s58 offen offset:896 nt
    buffer_load_dwordx4 v[148:151], v30, s[36:39], s58 offen offset:1152 nt
    buffer_load_dwordx4 v[88:91], v30, s[36:39], s58 offen offset:1792 nt
    buffer_load_dwordx4 v[152:155], v30, s[36:39], s58 offen offset:2048 nt
    buffer_load_dwordx4 v[92:95], v30, s[36:39], s58 offen offset:2688 nt
    buffer_load_dwordx4 v[156:159], v30, s[36:39], s58 offen offset:2944 nt
    s_add_u32 s58, s58, 3584
    buffer_load_dwordx4 v[96:99], v30, s[36:39], s58 offen offset:0 nt
    buffer_load_dwordx4 v[160:163], v30, s[36:39], s58 offen offset:256 nt
    buffer_load_dwordx4 v[100:103], v30, s[36:39], s58 offen offset:896 nt
    buffer_load_dwordx4 v[164:167], v30, s[36:39], s58 offen offset:1152 nt
    buffer_load_dwordx4 v[104:107], v30, s[36:39], s58 offen offset:1792 nt
    buffer_load_dwordx4 v[168:171], v30, s[36:39], s58 offen offset:2048 nt
    buffer_load_dwordx4 v[108:111], v30, s[36:39], s58 offen offset:2688 nt
    buffer_load_dwordx4 v[172:175], v30, s[36:39], s58 offen offset:2944 nt
    s_add_u32 s58, s58, 3584
    buffer_load_dwordx4 v[112:115], v30, s[36:39], s58 offen offset:0 nt
    buffer_load_dwordx4 v[176:179], v30, s[36:39], s58 offen offset:256 nt
    buffer_load_dwordx4 v[116:119], v30, s[36:39], s58 offen offset:896 nt
    buffer_load_dwordx4 v[180:183], v30, s[36:39], s58 offen offset:1152 nt
    buffer_load_dwordx4 v[120:123], v30, s[36:39], s58 offen offset:1792 nt
    buffer_load_dwordx4 v[184:187], v30, s[36:39], s58 offen offset:2048 nt
    buffer_load_dwordx4 v[124:127], v30, s[36:39], s58 offen offset:2688 nt
    buffer_load_dwordx4 v[188:191], v30, s[36:39], s58 offen offset:2944 nt
    s_branch L_f_w2
L_tail:
    s_and_b32 s58, s2, 127
    s_lshr_b32 s33, s58, 2
    s_bfe_u32 s59, s33, 0x20001
    s_and_b32 s58, s58, 3
    s_cmp_eq_u32 s58, s59
    s_cselect_b32 s33, s33, 255
    s_mov_b32 s76, 400000
L_lw_66:
    ds_read_b32 v10, v8 offset:0
    s_waitcnt lgkmcnt(0)
    v_readfirstlane_b32 s58, v10
    s_nop 0
    s_cmp_lg_u32 s58, 0
    s_cbranch_scc1 L_lwd_67
    s_sleep 32
    s_sub_u32 s76, s76, 1
    s_cmp_gt_i32 s76, 0
    s_cbranch_scc1 L_lw_66
L_lwd_67:
    s_cmp_ge_u32 s33, 28
    s_cbranch_scc1 L_tailw
    s_mov_b32 s36, s4
    s_mov_b32 s37, s5
    s_mov_b32 s38, 1792
    s_mov_b32 s39, 0x00020000
    v_lshrrev_b32 v1, 2, v0
    v_and_b32 v10, 3, v0
    v_lshlrev_b32 v21, 12, v1
    v_lshl_add_u32 v21, v10, 4, v21
    s_lshl_b32 s67, s31, 18
    s_lshl_b32 s59, s33, 6
    s_add_u32 s67, s67, s59
    s_add_u32 s67, s67, 3145728
    s_lshl_b32 s65, s31, 11
    s_add_u32 s65, s65, s59
    s_add_u32 s65, s65, 4194304
    s_mul_i32 s68, s31, 896
    s_lshl_b32 s59, s33, 5
    s_add_u32 s68, s68, s59
    v_lshlrev_b32 v22, 3, v10
    buffer_load_dwordx2 v[24:25], v22, s[36:39], s68 offen
    s_mov_b32 s76, 50000
L_t_half:
    ds_read_b32 v10, v8 offset:16
    s_waitcnt lgkmcnt(0)
    v_readfirstlane_b32 s58, v10
    s_nop 0
    s_cmp_ge_u32 s58, 32
    s_cbranch_scc1 L_t_top
    s_sleep 100
    s_sub_u32 s76, s76, 1
    s_cmp_gt_i32 s76, 0
    s_cbranch_scc1 L_t_half
L_t_top:
    s_mov_b32 s48, s24
    s_mov_b32 s49, s25
    s_mov_b32 s50, 256
    s_mov_b32 s51, 0x00020000
    buffer_load_dword v10, v8, s[48:51], 0 offen sc1
    s_waitcnt vmcnt(0)
    v_readfirstlane_b32 s58, v10
    s_nop 0
    s_cmp_ge_u32 s58, 8
    s_cbranch_scc1 L_t_yb
    s_sleep 100
    s_sub_u32 s76, s76, 1
    s_cmp_gt_i32 s76, 0
    s_cbranch_scc1 L_t_top
L_t_yb:
    s_mov_b32 s46, 4308992
    s_mov_b32 s76, 50000
L_yb_poll:
    s_mov_b32 s59, s65
    buffer_load_dwordx4 v[192:195], v21, s[44:47], s59 offen sc1
    s_add_u32 s59, s59, 65536
    buffer_load_dwordx4 v[196:199], v21, s[44:47], s59 offen sc1
    s_waitcnt vmcnt(0)
    v_max_u32 v14, v192, v193
    v_max3_u32 v14, v14, v194, v195
    v_max3_u32 v14, v14, v196, v197
    v_max3_u32 v14, v14, v198, v199
    v_cmp_eq_u32 vcc, -1, v14
    s_cbranch_vccz L_yb_done
    s_mov_b64 exec, vcc
    s_sleep 64
    s_sub_u32 s76, s76, 1
    s_cmp_gt_i32 s76, 0
    s_cbranch_scc1 L_yb_poll
L_yb_done:
    s_mov_b64 exec, -1
    v_add_f32 v224, v192, v196
    v_add_f32 v225, v193, v197
    v_add_f32 v226, v194, v198
    v_add_f32 v227, v195, v199
    v_add_f32_dpp v224, v224, v224 row_ror:8 row_mask:0xf bank_mask:0xf
    v_add_f32_dpp v225, v225, v225 row_ror:8 row_mask:0xf bank_mask:0xf
    v_add_f32_dpp v226, v226, v226 row_ror:8 row_mask:0xf bank_mask:0xf
    v_add_f32_dpp v227, v227, v227 row_ror:8 row_mask:0xf bank_mask:0xf
    v_add_f32_dpp v224, v224, v224 row_ror:4 row_mask:0xf bank_mask:0xf
    v_add_f32_dpp v225, v225, v225 row_ror:4 row_mask:0xf bank_mask:0xf
    v_add_f32_dpp v226, v226, v226 row_ror:4 row_mask:0xf bank_mask:0xf
    v_add_f32_dpp v227, v227, v227 row_ror:4 row_mask:0xf bank_mask:0xf
    v_mov_b32 v228, v224
    v_mov_b32 v229, v225
    v_mov_b32 v230, v226
    v_mov_b32 v231, v227
    v_permlane16_swap_b32 v228, v224
    v_permlane16_swap_b32 v229, v225
    v_permlane16_swap_b32 v230, v226
    v_permlane16_swap_b32 v231, v227
    v_add_f32 v224, v228, v224
    v_add_f32 v225, v229, v225
    v_add_f32 v226, v230, v226
    v_add_f32 v227, v231, v227
    v_mov_b32 v228, v224
    v_mov_b32 v229, v225
    v_mov_b32 v230, v226
    v_mov_b32 v231, v227
    v_permlane32_swap_b32 v228, v224
    v_permlane32_swap_b32 v229, v225
    v_permlane32_swap_b32 v230, v226
    v_permlane32_swap_b32 v231, v227
    v_add_f32 v224, v228, v224
    v_add_f32 v225, v229, v225
    v_add_f32 v226, v230, v226
    v_add_f32 v227, v231, v227
    v_cvt_pk_bf16_f32 v26, v224, v225
    v_cvt_pk_bf16_f32 v27, v226, v227
L_tailw:
    s_sub_u32 s34, s28, 4
    s_cmp_eq_u32 s28, 2
    s_cselect_b32 s34, 3, s34
    s_mov_b32 s74, 0x01000100
    s_mov_b32 s75, 0x03020302
    v_and_b32 v1, 1, v0
    v_lshlrev_b32 v1, 4, v1
    v_mov_b32 v52, 0xffff
    v_lshlrev_b32 v52, v1, v52
    v_bfe_u32 v1, v0, 1, 2
    v_cmp_eq_u32 vcc, 0, v1
    s_nop 1
    v_cndmask_b32 v4, 0, v52, vcc
    v_cmp_eq_u32 vcc, 1, v1
    s_nop 1
    v_cndmask_b32 v5, 0, v52, vcc
    v_cmp_eq_u32 vcc, 2, v1
    s_nop 1
    v_cndmask_b32 v6, 0, v52, vcc
    v_cmp_eq_u32 vcc, 3, v1
    s_nop 1
    v_cndmask_b32 v7, 0, v52, vcc
    v_and_b32 v2, 15, v0
    v_lshrrev_b32 v3, 4, v0
    s_mov_b32 s36, s12
    s_mov_b32 s37, s13
    s_mov_b32 s38, 3670016
    s_mov_b32 s39, 0x00020000
    v_mul_u32_u24 v13, 7168, v3
    v_lshl_add_u32 v13, v2, 4, v13
    s_and_b32 s69, s2, 127
    s_mul_i32 s69, s69, 28672
    s_lshl_b32 s59, s34, 8
    s_add_u32 s69, s69, s59
    v_lshlrev_b32 v1, 7, v2
    v_lshl_add_u32 v1, v3, 5, v1
    v_lshlrev_b32 v15, 3, v2
    s_lshl_b32 s64, s2, 11
    s_add_u32 s64, s64, 1048576
    s_lshl_b32 s65, s2, 7
    s_add_u32 s65, s65, 2097152
    v_lshlrev_b32 v11, 5, v2
    v_lshl_add_u32 v11, v3, 4, v11
    v_cmp_gt_u32 vcc, 32, v0
    s_nop 1
    v_cndmask_b32 v11, v9, v11, vcc
    s_lshl_b32 s66, s2, 11
    s_lshl_b32 s59, s34, 9
    s_add_u32 s66, s66, s59
    s_add_u32 s66, s66, 3145728
    v_lshlrev_b32 v16, 4, v3
    s_mov_b32 s40, s22
    s_mov_b32 s41, s23
    s_mov_b32 s42, 1792
    s_mov_b32 s43, 0x00020000
    v_lshrrev_b32 v20, 2, v0
    v_lshlrev_b32 v20, 11, v20
    v_and_b32 v22, 3, v0
    v_lshl_add_u32 v20, v22, 4, v20
    v_lshlrev_b32 v22, 3, v22
    v_cmp_gt_u32 vcc, 4, v0
    s_nop 1
    v_cndmask_b32 v22, v9, v22, vcc
    v_mov_b32 v32, -1
    v_mov_b32 v33, -1
    v_mov_b32 v34, -1
    v_mov_b32 v35, -1
    v_mov_b32 v36, -1
    v_mov_b32 v37, -1
    v_mov_b32 v38, -1
    v_mov_b32 v39, -1
    v_mov_b32 v40, -1
    v_mov_b32 v41, -1
    v_mov_b32 v192, -1
    v_mov_b32 v193, -1
    v_mov_b32 v194, -1
    v_mov_b32 v195, -1
    v_mov_b32 v196, -1
    v_mov_b32 v197, -1
    v_mov_b32 v198, -1
    v_mov_b32 v199, -1
    v_mov_b32 v200, -1
    v_mov_b32 v201, -1
    v_mov_b32 v202, -1
    v_mov_b32 v203, -1
    v_mov_b32 v204, -1
    v_mov_b32 v205, -1
    v_mov_b32 v206, -1
    v_mov_b32 v207, -1
    v_mov_b32 v208, -1
    v_mov_b32 v209, -1
    v_mov_b32 v210, -1
    v_mov_b32 v211, -1
    v_mov_b32 v212, -1
    v_mov_b32 v213, -1
    v_mov_b32 v214, -1
    v_mov_b32 v215, -1
    v_mov_b32 v216, -1
    v_mov_b32 v217, -1
    v_mov_b32 v218, -1
    v_mov_b32 v219, -1
    v_mov_b32 v220, -1
    v_mov_b32 v221, -1
    v_mov_b32 v222, -1
    v_mov_b32 v223, -1
    s_mov_b32 s76, 400000
    s_cmp_eq_u32 s28, 2
    s_cbranch_scc1 L_tw_wait
    s_waitcnt lgkmcnt(0)
    s_barrier
    s_cmp_eq_u32 s28, 7
    s_cbranch_scc1 L_p1_poll
L_tw_wait:
    ds_read_b32 v19, v8 offset:12
    s_waitcnt lgkmcnt(0)
    v_readfirstlane_b32 s58, v19
    s_nop 0
    s_cmp_ge_u32 s58, 84
    s_cbranch_scc1 L_tw_go
    s_sub_u32 s76, s76, 1
    s_cmp_gt_i32 s76, 0
    s_cbranch_scc1 L_tw_wait
L_tw_go:
    buffer_load_dwordx4 v[64:67], v13, s[36:39], s69 offen offset:0 nt
    buffer_load_dwordx4 v[68:71], v13, s[36:39], s69 offen offset:896 nt
    buffer_load_dwordx4 v[72:75], v13, s[36:39], s69 offen offset:1792 nt
    buffer_load_dwordx4 v[76:79], v13, s[36:39], s69 offen offset:2688 nt
    s_add_u32 s69, s69, 3584
    buffer_load_dwordx4 v[80:83], v13, s[36:39], s69 offen offset:0 nt
    buffer_load_dwordx4 v[84:87], v13, s[36:39], s69 offen offset:896 nt
    buffer_load_dwordx4 v[88:91], v13, s[36:39], s69 offen offset:1792 nt
    buffer_load_dwordx4 v[92:95], v13, s[36:39], s69 offen offset:2688 nt
L_o_poll:
    ds_read_b128 v[42:45], v16 offset:64
    s_waitcnt lgkmcnt(0)
    v_max3_u32 v12, v42, v43, v44
    v_max_u32 v12, v12, v45
    v_cmp_eq_u32 vcc, -1, v12
    s_cbranch_vccz L_y_mma
    s_sub_u32 s76, s76, 1
    s_cmp_gt_i32 s76, 0
    s_cbranch_scc1 L_o_poll
    s_branch L_y_mma
L_p1_poll:
    buffer_load_dwordx4 v[32:35], v1, s[44:47], s64 offen sc1
    buffer_load_dwordx4 v[36:39], v1, s[44:47], s64 offen offset:16 sc1
    s_waitcnt vmcnt(0)
    v_max3_u32 v12, v32, v33, v34
    v_max3_u32 v12, v12, v35, v36
    v_max3_u32 v12, v12, v37, v38
    v_max_u32 v12, v12, v39
    v_cmp_eq_u32 vcc, -1, v12
    s_cbranch_vccz L_p1_done
    s_mov_b64 exec, vcc
    s_sub_u32 s76, s76, 1
    s_cmp_gt_i32 s76, 0
    s_cbranch_scc1 L_p1_poll
L_p1_done:
    s_mov_b64 exec, -1
    v_add_f32_dpp v97, v32, v32 row_ror:8 row_mask:0xf bank_mask:0xf
    v_add_f32_dpp v98, v33, v33 row_ror:8 row_mask:0xf bank_mask:0xf
    v_add_f32_dpp v99, v34, v34 row_ror:8 row_mask:0xf bank_mask:0xf
    v_add_f32_dpp v100, v35, v35 row_ror:8 row_mask:0xf bank_mask:0xf
    v_add_f32_dpp v101, v36, v36 row_ror:8 row_mask:0xf bank_mask:0xf
    v_add_f32_dpp v102, v37, v37 row_ror:8 row_mask:0xf bank_mask:0xf
    v_add_f32_dpp v103, v38, v38 row_ror:8 row_mask:0xf bank_mask:0xf
    v_add_f32_dpp v104, v39, v39 row_ror:8 row_mask:0xf bank_mask:0xf
    v_add_f32_dpp v97, v97, v97 row_ror:4 row_mask:0xf bank_mask:0xf
    v_add_f32_dpp v98, v98, v98 row_ror:4 row_mask:0xf bank_mask:0xf
    v_add_f32_dpp v99, v99, v99 row_ror:4 row_mask:0xf bank_mask:0xf
    v_add_f32_dpp v100, v100, v100 row_ror:4 row_mask:0xf bank_mask:0xf
    v_add_f32_dpp v101, v101, v101 row_ror:4 row_mask:0xf bank_mask:0xf
    v_add_f32_dpp v102, v102, v102 row_ror:4 row_mask:0xf bank_mask:0xf
    v_add_f32_dpp v103, v103, v103 row_ror:4 row_mask:0xf bank_mask:0xf
    v_add_f32_dpp v104, v104, v104 row_ror:4 row_mask:0xf bank_mask:0xf
    v_add_f32_dpp v97, v97, v97 row_ror:2 row_mask:0xf bank_mask:0xf
    v_add_f32_dpp v98, v98, v98 row_ror:2 row_mask:0xf bank_mask:0xf
    v_add_f32_dpp v99, v99, v99 row_ror:2 row_mask:0xf bank_mask:0xf
    v_add_f32_dpp v100, v100, v100 row_ror:2 row_mask:0xf bank_mask:0xf
    v_add_f32_dpp v101, v101, v101 row_ror:2 row_mask:0xf bank_mask:0xf
    v_add_f32_dpp v102, v102, v102 row_ror:2 row_mask:0xf bank_mask:0xf
    v_add_f32_dpp v103, v103, v103 row_ror:2 row_mask:0xf bank_mask:0xf
    v_add_f32_dpp v104, v104, v104 row_ror:2 row_mask:0xf bank_mask:0xf
    v_add_f32_dpp v97, v97, v97 row_ror:1 row_mask:0xf bank_mask:0xf
    v_add_f32_dpp v98, v98, v98 row_ror:1 row_mask:0xf bank_mask:0xf
    v_add_f32_dpp v99, v99, v99 row_ror:1 row_mask:0xf bank_mask:0xf
    v_add_f32_dpp v100, v100, v100 row_ror:1 row_mask:0xf bank_mask:0xf
    v_add_f32_dpp v101, v101, v101 row_ror:1 row_mask:0xf bank_mask:0xf
    v_add_f32_dpp v102, v102, v102 row_ror:1 row_mask:0xf bank_mask:0xf
    v_add_f32_dpp v103, v103, v103 row_ror:1 row_mask:0xf bank_mask:0xf
    v_add_f32_dpp v104, v104, v104 row_ror:1 row_mask:0xf bank_mask:0xf
    v_cvt_pk_bf16_f32 v42, v97, v98
    v_cvt_pk_bf16_f32 v43, v99, v100
    v_cvt_pk_bf16_f32 v44, v101, v102
    v_cvt_pk_bf16_f32 v45, v103, v104
    v_min_u32 v42, -2, v42
    v_min_u32 v43, -2, v43
    v_min_u32 v44, -2, v44
    v_min_u32 v45, -2, v45
    ds_write_b128 v16, v[42:45] offset:64
    s_branch L_fin
L_y_mma:
    s_waitcnt vmcnt(0)
L_y_go:
    v_perm_b32 v52, v42, v42, s74
    v_and_b32 v48, v52, v4
    v_and_b32 v49, v52, v5
    v_and_b32 v50, v52, v6
    v_and_b32 v51, v52, v7
    s_nop 1
    v_mfma_f32_16x16x32_bf16 v[108:111], v[48:51], v[64:67], 0
    v_perm_b32 v60, v42, v42, s75
    v_and_b32 v56, v60, v4
    v_and_b32 v57, v60, v5
    v_and_b32 v58, v60, v6
    v_and_b32 v59, v60, v7
    s_nop 1
    v_mfma_f32_16x16x32_bf16 v[108:111], v[56:59], v[68:71], v[108:111]
    v_perm_b32 v52, v43, v43, s74
    v_and_b32 v48, v52, v4
    v_and_b32 v49, v52, v5
    v_and_b32 v50, v52, v6
    v_and_b32 v51, v52, v7
    s_nop 1
    v_mfma_f32_16x16x32_bf16 v[108:111], v[48:51], v[72:75], v[108:111]
    v_perm_b32 v60, v43, v43, s75
    v_and_b32 v56, v60, v4
    v_and_b32 v57, v60, v5
    v_and_b32 v58, v60, v6
    v_and_b32 v59, v60, v7
    s_nop 1
    v_mfma_f32_16x16x32_bf16 v[108:111], v[56:59], v[76:79], v[108:111]
    v_perm_b32 v52, v44, v44, s74
    v_and_b32 v48, v52, v4
    v_and_b32 v49, v52, v5
    v_and_b32 v50, v52, v6
    v_and_b32 v51, v52, v7
    s_nop 1
    v_mfma_f32_16x16x32_bf16 v[108:111], v[48:51], v[80:83], v[108:111]
    v_perm_b32 v60, v44, v44, s75
    v_and_b32 v56, v60, v4
    v_and_b32 v57, v60, v5
    v_and_b32 v58, v60, v6
    v_and_b32 v59, v60, v7
    s_nop 1
    v_mfma_f32_16x16x32_bf16 v[108:111], v[56:59], v[84:87], v[108:111]
    v_perm_b32 v52, v45, v45, s74
    v_and_b32 v48, v52, v4
    v_and_b32 v49, v52, v5
    v_and_b32 v50, v52, v6
    v_and_b32 v51, v52, v7
    s_nop 1
    v_mfma_f32_16x16x32_bf16 v[108:111], v[48:51], v[88:91], v[108:111]
    v_perm_b32 v60, v45, v45, s75
    v_and_b32 v56, v60, v4
    v_and_b32 v57, v60, v5
    v_and_b32 v58, v60, v6
    v_and_b32 v59, v60, v7
    s_nop 1
    v_mfma_f32_16x16x32_bf16 v[108:111], v[56:59], v[92:95], v[108:111]
    s_nop 7
    v_min_u32 v108, -2, v108
    v_min_u32 v109, -2, v109
    v_min_u32 v110, -2, v110
    v_min_u32 v111, -2, v111
    buffer_store_dwordx4 v[108:111], v11, s[44:47], s66 offen sc1
    s_cmp_lg_u32 s28, 7
    s_cbranch_scc1 L_exit
L_fin:
    s_cmp_ge_u32 s33, 28
    s_cbranch_scc1 L_exit
    s_mov_b32 s76, 50000
L_y_poll:
    s_mov_b32 s59, s67
    buffer_load_dwordx4 v[192:195], v20, s[44:47], s59 offen sc1
    s_add_u32 s59, s59, 32768
    buffer_load_dwordx4 v[196:199], v20, s[44:47], s59 offen sc1
    s_add_u32 s59, s59, 32768
    buffer_load_dwordx4 v[200:203], v20, s[44:47], s59 offen sc1
    s_add_u32 s59, s59, 32768
    buffer_load_dwordx4 v[204:207], v20, s[44:47], s59 offen sc1
    s_add_u32 s59, s59, 32768
    buffer_load_dwordx4 v[208:211], v20, s[44:47], s59 offen sc1
    s_add_u32 s59, s59, 32768
    buffer_load_dwordx4 v[212:215], v20, s[44:47], s59 offen sc1
    s_add_u32 s59, s59, 32768
    buffer_load_dwordx4 v[216:219], v20, s[44:47], s59 offen sc1
    s_add_u32 s59, s59, 32768
    buffer_load_dwordx4 v[220:223], v20, s[44:47], s59 offen sc1
    s_waitcnt vmcnt(0)
    v_max_u32 v14, v192, v193
    v_max3_u32 v14, v14, v194, v195
    v_max3_u32 v14, v14, v196, v197
    v_max3_u32 v14, v14, v198, v199
    v_max3_u32 v14, v14, v200, v201
    v_max3_u32 v14, v14, v202, v203
    v_max3_u32 v14, v14, v204, v205
    v_max3_u32 v14, v14, v206, v207
    v_max3_u32 v14, v14, v208, v209
    v_max3_u32 v14, v14, v210, v211
    v_max3_u32 v14, v14, v212, v213
    v_max3_u32 v14, v14, v214, v215
    v_max3_u32 v14, v14, v216, v217
    v_max3_u32 v14, v14, v218, v219
    v_max3_u32 v14, v14, v220, v221
    v_max3_u32 v14, v14, v222, v223
    v_cmp_eq_u32 vcc, -1, v14
    s_cbranch_vccz L_y_done
    s_mov_b64 exec, vcc
    s_sub_u32 s76, s76, 1
    s_cmp_gt_i32 s76, 0
    s_cbranch_scc1 L_y_poll
L_y_done:
    s_mov_b64 exec, -1
    v_add_f32 v224, v192, v196
    v_add_f32 v225, v193, v197
    v_add_f32 v226, v194, v198
    v_add_f32 v227, v195, v199
    v_add_f32 v224, v224, v200
    v_add_f32 v225, v225, v201
    v_add_f32 v226, v226, v202
    v_add_f32 v227, v227, v203
    v_add_f32 v224, v224, v204
    v_add_f32 v225, v225, v205
    v_add_f32 v226, v226, v206
    v_add_f32 v227, v227, v207
    v_add_f32 v224, v224, v208
    v_add_f32 v225, v225, v209
    v_add_f32 v226, v226, v210
    v_add_f32 v227, v227, v211
    v_add_f32 v224, v224, v212
    v_add_f32 v225, v225, v213
    v_add_f32 v226, v226, v214
    v_add_f32 v227, v227, v215
    v_add_f32 v224, v224, v216
    v_add_f32 v225, v225, v217
    v_add_f32 v226, v226, v218
    v_add_f32 v227, v227, v219
    v_add_f32 v224, v224, v220
    v_add_f32 v225, v225, v221
    v_add_f32 v226, v226, v222
    v_add_f32 v227, v227, v223
    v_add_f32_dpp v224, v224, v224 row_ror:8 row_mask:0xf bank_mask:0xf
    v_add_f32_dpp v225, v225, v225 row_ror:8 row_mask:0xf bank_mask:0xf
    v_add_f32_dpp v226, v226, v226 row_ror:8 row_mask:0xf bank_mask:0xf
    v_add_f32_dpp v227, v227, v227 row_ror:8 row_mask:0xf bank_mask:0xf
    v_add_f32_dpp v224, v224, v224 row_ror:4 row_mask:0xf bank_mask:0xf
    v_add_f32_dpp v225, v225, v225 row_ror:4 row_mask:0xf bank_mask:0xf
    v_add_f32_dpp v226, v226, v226 row_ror:4 row_mask:0xf bank_mask:0xf
    v_add_f32_dpp v227, v227, v227 row_ror:4 row_mask:0xf bank_mask:0xf
    v_mov_b32 v228, v224
    v_mov_b32 v229, v225
    v_mov_b32 v230, v226
    v_mov_b32 v231, v227
    v_permlane16_swap_b32 v228, v224
    v_permlane16_swap_b32 v229, v225
    v_permlane16_swap_b32 v230, v226
    v_permlane16_swap_b32 v231, v227
    v_add_f32 v224, v228, v224
    v_add_f32 v225, v229, v225
    v_add_f32 v226, v230, v226
    v_add_f32 v227, v231, v227
    v_mov_b32 v228, v224
    v_mov_b32 v229, v225
    v_mov_b32 v230, v226
    v_mov_b32 v231, v227
    v_permlane32_swap_b32 v228, v224
    v_permlane32_swap_b32 v229, v225
    v_permlane32_swap_b32 v230, v226
    v_permlane32_swap_b32 v231, v227
    v_add_f32 v224, v228, v224
    v_add_f32 v225, v229, v225
    v_add_f32 v226, v230, v226
    v_add_f32 v227, v231, v227
    v_cvt_pk_bf16_f32 v28, v224, v225
    v_cvt_pk_bf16_f32 v29, v226, v227
    v_lshlrev_b32 v112, 16, v24
    v_and_b32 v113, 0xffff0000, v24
    v_lshlrev_b32 v114, 16, v28
    v_and_b32 v115, 0xffff0000, v28
    v_add_f32 v112, v112, v114
    v_add_f32 v113, v113, v115
    v_cvt_pk_bf16_f32 v116, v112, v113
    v_lshlrev_b32 v112, 16, v116
    v_and_b32 v113, 0xffff0000, v116
    v_lshlrev_b32 v114, 16, v26
    v_and_b32 v115, 0xffff0000, v26
    v_add_f32 v112, v112, v114
    v_add_f32 v113, v113, v115
    v_cvt_pk_bf16_f32 v30, v112, v113
    v_lshlrev_b32 v112, 16, v25
    v_and_b32 v113, 0xffff0000, v25
    v_lshlrev_b32 v114, 16, v29
    v_and_b32 v115, 0xffff0000, v29
    v_add_f32 v112, v112, v114
    v_add_f32 v113, v113, v115
    v_cvt_pk_bf16_f32 v116, v112, v113
    v_lshlrev_b32 v112, 16, v116
    v_and_b32 v113, 0xffff0000, v116
    v_lshlrev_b32 v114, 16, v27
    v_and_b32 v115, 0xffff0000, v27
    v_add_f32 v112, v112, v114
    v_add_f32 v113, v113, v115
    v_cvt_pk_bf16_f32 v31, v112, v113
    buffer_store_dwordx2 v[30:31], v22, s[40:43], s68 offen
L_exit:
L_end:
    s_endpgm
.section .rodata,"a"
.p2align 6
.amdhsa_kernel parallel_sum__gqa_block_cached__glu_gated_swiglu__decode_kernel
  .amdhsa_next_free_vgpr 256
  .amdhsa_next_free_sgpr 96
  .amdhsa_accum_offset 256
  .amdhsa_group_segment_fixed_size 0
  .amdhsa_kernarg_size 96
  .amdhsa_user_sgpr_count 2
  .amdhsa_user_sgpr_kernarg_segment_ptr 1
  .amdhsa_system_sgpr_workgroup_id_x 1
  .amdhsa_float_denorm_mode_32 3
.end_amdhsa_kernel
```
